```python
import torch

def _softmax(x, axis=-1):
    return torch.softmax(x, dim=axis)
def _gelu(x):
    return torch.nn.functional.gelu(x, approximate="tanh")
def _silu(x):
    return torch.nn.functional.silu(x)
def _sigmoid(x):
    return torch.sigmoid(x)
def _layernorm(x, axis=-1, eps=1e-5):
    m = x.mean(dim=axis, keepdim=True)
    v = x.var(dim=axis, keepdim=True, unbiased=False)
    return (x - m) / torch.sqrt(v + eps)
def _scatter_add(tgt, idx, src, axis=0):
    return tgt.clone().index_add_(axis, idx, src)
def _segment_sum(src, seg, n):
    out = torch.zeros((n,) + src.shape[1:], dtype=src.dtype)
    return out.index_add_(0, seg, src)
def _pad(x, pw):
    flat = tuple(v for pair in reversed(pw) for v in pair)
    return torch.nn.functional.pad(x, flat)

kernel_name = 'gather_scatter__graph_attention_gat__graph'

def setup_inputs():

    _w = (lambda a: (lambda t: t.to(torch.bfloat16) if t.is_floating_point() else t)(torch.as_tensor(a)))
    N, deg, D = 10000, 16, 256
    H = 4
    E = N * deg
    return {
        "x": _w((lambda *s: torch.randn(*s, dtype=torch.bfloat16) * 0.4)(N, D) * 0.1),
        "src": _w((lambda lo, hi, *s: torch.randint(lo, hi, s))(0, N, E).to(torch.int64)),
        "dst": _w((lambda lo, hi, *s: torch.randint(lo, hi, s))(0, N, E).to(torch.int64)),
        "w": _w((lambda *s: torch.randn(*s, dtype=torch.bfloat16) * 1.6)(H, D, D) * (1.0 / D ** 0.5)),
        "a_src": _w((lambda *s: torch.randn(*s, dtype=torch.bfloat16) * 1.6)(H, D) * 0.1),
        "a_dst": _w((lambda *s: torch.randn(*s, dtype=torch.bfloat16) * 1.6)(H, D) * 0.1),
    }

def reference(x, src, dst, w, a_src, a_dst):
    N, D = x.shape
    H = w.shape[0]
    h = torch.einsum('nd,hdf->nhf', x, w)
    hs = h[src]
    hd = h[dst]
    e = torch.einsum('ehf,hf->eh', hs, a_src) + torch.einsum('ehf,hf->eh', hd, a_dst)
    e = torch.where(e > 0, e, 0.2 * e)
    exp_e = torch.exp(e)
    denom = _segment_sum(exp_e, dst, N) + 1e-9
    alpha = exp_e / denom[dst]
    out = _segment_sum(alpha[:, :, None] * hs, dst, N)
    return out.mean(1)
```

```asm
; @launch kernel=gat_prep_kernel grid=(112,1,1) block=(640,1,1) lds=43520
; @launch kernel=gather_scatter__graph_attention_gat__graph_kernel grid=(250,1,1) block=(512,1,1) lds=162432
.amdgcn_target "amdgcn-amd-amdhsa--gfx950"
.text
.globl gat_prep_kernel
.p2align 8
.type gat_prep_kernel,@function
gat_prep_kernel:
    s_cmp_ge_u32 s2, 112
    s_cbranch_scc1 PREP_END
    s_cmp_ge_u32 s2, 64
    s_cbranch_scc1 PREP_NB
    s_load_dwordx4 s[4:7], s[0:1], 8
    s_load_dwordx2 s[10:11], s[0:1], 64
    s_load_dwordx2 s[12:13], s[0:1], 0
    v_lshlrev_b32 v1, 4, v0
    v_mov_b32 v4, -1
    v_mov_b32 v5, -1
    v_mov_b32 v6, -1
    v_mov_b32 v7, -1
    v_lshlrev_b32 v2, 2, v0
    v_mov_b32 v3, 0
    s_mul_i32 s28, s2, 10000
    v_add_u32 v30, s28, v1
    s_waitcnt lgkmcnt(0)
    s_mov_b32 s20, s6
    s_mov_b32 s21, s7
    s_mov_b32 s22, 640000
    s_mov_b32 s23, 0x00020000
    buffer_load_dwordx4 v[8:11], v30, s[20:23], 0 offen
    s_mov_b32 s16, s4
    s_mov_b32 s17, s5
    s_mov_b32 s18, 640000
    s_mov_b32 s19, 0x00020000
    buffer_load_dwordx4 v[12:15], v30, s[16:19], 0 offen
    s_mov_b32 s24, s10
    s_mov_b32 s25, s11
    s_mov_b32 s26, 2621440
    s_mov_b32 s27, 0x00020000
    ds_write_b128 v1, v[4:7] offset:0
    ds_write_b128 v1, v[4:7] offset:10240
    ds_write_b128 v1, v[4:7] offset:20480
    ds_write_b128 v1, v[4:7] offset:30720
    ds_write_b32 v2, v3 offset:40960
    v_cmp_gt_u32 vcc, 625, v0
    s_mov_b32 s29, 52429
    v_mov_b32 v3, 1
    v_mov_b32 v28, 32000
    s_waitcnt lgkmcnt(0)
    s_barrier
    s_and_saveexec_b64 s[30:31], vcc
    s_waitcnt vmcnt(1)
    v_mul_u32_u24 v16, s29, v8
    v_lshrrev_b32 v16, 21, v16
    v_lshlrev_b32 v20, 2, v16
    ds_add_rtn_u32 v24, v20, v3 offset:40960
    v_mul_u32_u24 v17, s29, v9
    v_lshrrev_b32 v17, 21, v17
    v_lshlrev_b32 v21, 2, v17
    ds_add_rtn_u32 v25, v21, v3 offset:40960
    v_mul_u32_u24 v18, s29, v10
    v_lshrrev_b32 v18, 21, v18
    v_lshlrev_b32 v22, 2, v18
    ds_add_rtn_u32 v26, v22, v3 offset:40960
    v_mul_u32_u24 v19, s29, v11
    v_lshrrev_b32 v19, 21, v19
    v_lshlrev_b32 v23, 2, v19
    ds_add_rtn_u32 v27, v23, v3 offset:40960
    s_waitcnt vmcnt(0)
    v_mul_u32_u24 v4, 40, v16
    v_sub_u32 v4, v8, v4
    v_lshl_or_b32 v12, v12, 9, v4
    v_lshlrev_b32 v16, 7, v16
    v_mul_u32_u24 v4, 40, v17
    v_sub_u32 v4, v9, v4
    v_lshl_or_b32 v13, v13, 9, v4
    v_lshlrev_b32 v17, 7, v17
    v_mul_u32_u24 v4, 40, v18
    v_sub_u32 v4, v10, v4
    v_lshl_or_b32 v14, v14, 9, v4
    v_lshlrev_b32 v18, 7, v18
    v_mul_u32_u24 v4, 40, v19
    v_sub_u32 v4, v11, v4
    v_lshl_or_b32 v15, v15, 9, v4
    v_lshlrev_b32 v19, 7, v19
    s_waitcnt lgkmcnt(3)
    v_cmp_gt_u32 vcc, 32, v24
    v_lshl_add_u32 v4, v24, 2, v16
    s_nop 0
    v_cndmask_b32 v20, v28, v4, vcc
    s_waitcnt lgkmcnt(2)
    v_cmp_gt_u32 vcc, 32, v25
    v_lshl_add_u32 v4, v25, 2, v17
    s_nop 0
    v_cndmask_b32 v21, v28, v4, vcc
    s_waitcnt lgkmcnt(1)
    v_cmp_gt_u32 vcc, 32, v26
    v_lshl_add_u32 v4, v26, 2, v18
    s_nop 0
    v_cndmask_b32 v22, v28, v4, vcc
    s_waitcnt lgkmcnt(0)
    v_cmp_gt_u32 vcc, 32, v27
    v_lshl_add_u32 v4, v27, 2, v19
    s_nop 0
    v_cndmask_b32 v23, v28, v4, vcc
    ds_write_b32 v20, v12
    ds_write_b32 v21, v13
    ds_write_b32 v22, v14
    ds_write_b32 v23, v15
    s_mov_b64 exec, s[30:31]
    s_lshl_b32 s28, s2, 7
    v_and_b32 v2, 7, v0
    v_lshrrev_b32 v3, 3, v0
    v_lshlrev_b32 v29, 2, v3
    v_lshlrev_b32 v4, 4, v2
    v_lshl_add_u32 v4, v3, 13, v4
    v_add_u32 v4, s28, v4
    v_cmp_eq_u32 s[32:33], 7, v2
    v_cmp_gt_u32 vcc, 80, v0
    s_mov_b64 s[34:35], vcc
    v_mov_b32 v5, 0x7ffffff0
    v_mov_b32 v6, -2
    s_waitcnt lgkmcnt(0)
    s_barrier
    ds_read_b128 v[8:11], v1 offset:0
    ds_read_b32 v24, v29 offset:40960
    ds_read_b128 v[12:15], v1 offset:10240
    ds_read_b32 v25, v29 offset:41280
    ds_read_b128 v[16:19], v1 offset:20480
    ds_read_b32 v26, v29 offset:41600
    ds_read_b128 v[20:23], v1 offset:30720
    ds_read_b32 v27, v29 offset:41920
    s_waitcnt lgkmcnt(6)
    v_cmp_lt_u32 vcc, 32, v24
    s_and_b64 vcc, vcc, s[32:33]
    v_add_u32 v7, 0, v4
    s_nop 0
    v_cndmask_b32 v11, v11, v6, vcc
    buffer_store_dwordx4 v[8:11], v7, s[24:27], 0 offen
    s_waitcnt lgkmcnt(4)
    v_cmp_lt_u32 vcc, 32, v25
    s_and_b64 vcc, vcc, s[32:33]
    v_add_u32 v7, 655360, v4
    s_nop 0
    v_cndmask_b32 v15, v15, v6, vcc
    buffer_store_dwordx4 v[12:15], v7, s[24:27], 0 offen
    s_waitcnt lgkmcnt(2)
    v_cmp_lt_u32 vcc, 32, v26
    s_and_b64 vcc, vcc, s[32:33]
    v_add_u32 v7, 1310720, v4
    s_nop 0
    v_cndmask_b32 v19, v19, v6, vcc
    buffer_store_dwordx4 v[16:19], v7, s[24:27], 0 offen
    s_waitcnt lgkmcnt(0)
    v_cmp_lt_u32 vcc, 32, v27
    s_and_b64 vcc, vcc, s[32:33]
    v_add_u32 v7, 1966080, v4
    v_cndmask_b32 v7, v5, v7, s[34:35]
    s_nop 0
    v_cndmask_b32 v23, v23, v6, vcc
    buffer_store_dwordx4 v[20:23], v7, s[24:27], 0 offen
    s_endpgm
PREP_NB:
    s_load_dwordx2 s[8:9], s[0:1], 24
    s_load_dwordx4 s[12:15], s[0:1], 32
    s_load_dwordx2 s[10:11], s[0:1], 64
    s_load_dwordx2 s[42:43], s[0:1], 0
    s_sub_u32 s28, s2, 64
    v_lshrrev_b32 v1, 6, v0
    s_nop 0
    s_and_b32 s27, s28, 0
    s_lshr_b32 s28, s28, 0
    v_readfirstlane_b32 s29, v1
    s_waitcnt lgkmcnt(0)
    s_mov_b32 s16, s8
    s_mov_b32 s17, s9
    s_mov_b32 s18, 524288
    s_mov_b32 s19, 0x00020000
    s_mov_b32 s36, s10
    s_mov_b32 s37, s11
    s_mov_b32 s38, 2621440
    s_mov_b32 s39, 0x00020000
    s_cmp_ge_u32 s2, 80
    s_cbranch_scc1 PREP_V
    s_cmp_ge_u32 s29, 8
    s_cbranch_scc1 PREP_END
    s_lshl_b32 s30, s28, 15
    s_add_u32 s33, s30, 16384
    v_lshrrev_b32 v1, 7, v0
    v_and_b32 v2, 127, v0
    v_lshlrev_b32 v3, 11, v1
    v_lshl_add_u32 v3, v2, 2, v3
    v_add_u32 v4, 8192, v3
    buffer_load_dword v8, v3, s[16:19], s30 offen offset:0
    buffer_load_dword v9, v3, s[16:19], s30 offen offset:512
    buffer_load_dword v10, v3, s[16:19], s30 offen offset:1024
    buffer_load_dword v11, v3, s[16:19], s30 offen offset:1536
    buffer_load_dword v12, v4, s[16:19], s30 offen offset:0
    buffer_load_dword v13, v4, s[16:19], s30 offen offset:512
    buffer_load_dword v14, v4, s[16:19], s30 offen offset:1024
    buffer_load_dword v15, v4, s[16:19], s30 offen offset:1536
    buffer_load_dword v16, v3, s[16:19], s33 offen offset:0
    buffer_load_dword v17, v3, s[16:19], s33 offen offset:512
    buffer_load_dword v18, v3, s[16:19], s33 offen offset:1024
    buffer_load_dword v19, v3, s[16:19], s33 offen offset:1536
    buffer_load_dword v20, v4, s[16:19], s33 offen offset:0
    buffer_load_dword v21, v4, s[16:19], s33 offen offset:512
    buffer_load_dword v22, v4, s[16:19], s33 offen offset:1024
    buffer_load_dword v23, v4, s[16:19], s33 offen offset:1536
    v_lshrrev_b32 v5, 4, v2
    v_lshlrev_b32 v5, 16, v5
    v_bfe_u32 v6, v2, 1, 1
    v_lshl_add_u32 v5, v6, 10, v5
    v_lshl_add_u32 v5, v1, 8, v5
    v_bfe_u32 v6, v2, 2, 2
    v_lshl_add_u32 v5, v6, 6, v5
    v_and_b32 v6, 1, v2
    v_lshl_add_u32 v5, v6, 5, v5
    s_lshl_b32 s31, s28, 12
    s_lshl_b32 s32, s27, 19
    s_add_u32 s31, s31, s32
    s_add_u32 s31, s31, 2097152
    s_mov_b32 s34, 0x05040100
    s_mov_b32 s35, 0x07060302
    s_waitcnt vmcnt(8)
    v_perm_b32 v24, v9, v8, s34
    v_perm_b32 v28, v9, v8, s35
    v_perm_b32 v25, v11, v10, s34
    v_perm_b32 v29, v11, v10, s35
    v_perm_b32 v26, v13, v12, s34
    v_perm_b32 v30, v13, v12, s35
    v_perm_b32 v27, v15, v14, s34
    v_perm_b32 v31, v15, v14, s35
    buffer_store_dwordx4 v[24:27], v5, s[36:39], s31 offen offset:0
    buffer_store_dwordx4 v[28:31], v5, s[36:39], s31 offen offset:16
    s_waitcnt vmcnt(2)
    v_perm_b32 v32, v17, v16, s34
    v_perm_b32 v36, v17, v16, s35
    v_perm_b32 v33, v19, v18, s34
    v_perm_b32 v37, v19, v18, s35
    v_perm_b32 v34, v21, v20, s34
    v_perm_b32 v38, v21, v20, s35
    v_perm_b32 v35, v23, v22, s34
    v_perm_b32 v39, v23, v22, s35
    buffer_store_dwordx4 v[32:35], v5, s[36:39], s31 offen offset:2048
    buffer_store_dwordx4 v[36:39], v5, s[36:39], s31 offen offset:2064
    s_endpgm
PREP_V:
    s_cmp_ge_u32 s29, 2
    s_cbranch_scc1 PREP_END
    s_sub_u32 s30, s2, 80
    s_lshl_b32 s30, s30, 1
    s_add_u32 s30, s30, s29
    s_lshr_b32 s31, s30, 4
    s_mov_b32 s20, s12
    s_mov_b32 s21, s13
    s_mov_b32 s22, 2048
    s_mov_b32 s23, 0x00020000
    s_mov_b32 s24, s14
    s_mov_b32 s25, s15
    s_mov_b32 s26, 2048
    s_mov_b32 s27, 0x00020000
    v_and_b32 v1, 63, v0
    v_and_b32 v2, 15, v1
    v_lshrrev_b32 v3, 4, v1
    v_lshlrev_b32 v4, 9, v2
    v_lshl_add_u32 v4, v3, 4, v4
    s_lshl_b32 s32, s30, 13
    v_lshlrev_b32 v5, 4, v3
    s_lshl_b32 s33, s31, 9
    buffer_load_dwordx4 v[8:11], v4, s[16:19], s32 offen offset:0
    buffer_load_dwordx4 v[12:15], v4, s[16:19], s32 offen offset:64
    buffer_load_dwordx4 v[16:19], v4, s[16:19], s32 offen offset:128
    buffer_load_dwordx4 v[20:23], v4, s[16:19], s32 offen offset:192
    buffer_load_dwordx4 v[24:27], v4, s[16:19], s32 offen offset:256
    buffer_load_dwordx4 v[28:31], v4, s[16:19], s32 offen offset:320
    buffer_load_dwordx4 v[32:35], v4, s[16:19], s32 offen offset:384
    buffer_load_dwordx4 v[36:39], v4, s[16:19], s32 offen offset:448
    v_and_b32 v6, 1, v2
    v_cmp_eq_u32 vcc, 0, v6
    s_mov_b64 s[40:41], exec
    s_mov_b64 exec, vcc
    buffer_load_dwordx4 v[40:43], v5, s[20:23], s33 offen offset:0
    buffer_load_dwordx4 v[44:47], v5, s[20:23], s33 offen offset:64
    buffer_load_dwordx4 v[48:51], v5, s[20:23], s33 offen offset:128
    buffer_load_dwordx4 v[52:55], v5, s[20:23], s33 offen offset:192
    buffer_load_dwordx4 v[56:59], v5, s[20:23], s33 offen offset:256
    buffer_load_dwordx4 v[60:63], v5, s[20:23], s33 offen offset:320
    buffer_load_dwordx4 v[64:67], v5, s[20:23], s33 offen offset:384
    buffer_load_dwordx4 v[68:71], v5, s[20:23], s33 offen offset:448
    s_andn2_b64 exec, s[40:41], vcc
    buffer_load_dwordx4 v[40:43], v5, s[24:27], s33 offen offset:0
    buffer_load_dwordx4 v[44:47], v5, s[24:27], s33 offen offset:64
    buffer_load_dwordx4 v[48:51], v5, s[24:27], s33 offen offset:128
    buffer_load_dwordx4 v[52:55], v5, s[24:27], s33 offen offset:192
    buffer_load_dwordx4 v[56:59], v5, s[24:27], s33 offen offset:256
    buffer_load_dwordx4 v[60:63], v5, s[24:27], s33 offen offset:320
    buffer_load_dwordx4 v[64:67], v5, s[24:27], s33 offen offset:384
    buffer_load_dwordx4 v[68:71], v5, s[24:27], s33 offen offset:448
    s_mov_b64 exec, s[40:41]
    s_lshl_b32 s32, s30, 5
    s_add_u32 s32, s32, 2064384
    v_lshlrev_b32 v7, 3, v3
    v_lshl_add_u32 v7, v6, 11, v7
    v_cmp_gt_u32 vcc, 2, v2
    s_mov_b32 s33, 1069066811
    s_waitcnt vmcnt(0)
    v_mfma_f32_16x16x32_bf16 v[72:75], v[8:11], v[40:43], 0
    v_mfma_f32_16x16x32_bf16 v[72:75], v[12:15], v[44:47], v[72:75]
    v_mfma_f32_16x16x32_bf16 v[72:75], v[16:19], v[48:51], v[72:75]
    v_mfma_f32_16x16x32_bf16 v[72:75], v[20:23], v[52:55], v[72:75]
    v_mfma_f32_16x16x32_bf16 v[72:75], v[24:27], v[56:59], v[72:75]
    v_mfma_f32_16x16x32_bf16 v[72:75], v[28:31], v[60:63], v[72:75]
    v_mfma_f32_16x16x32_bf16 v[72:75], v[32:35], v[64:67], v[72:75]
    v_mfma_f32_16x16x32_bf16 v[72:75], v[36:39], v[68:71], v[72:75]
    s_nop 7
    v_mul_f32 v72, s33, v72
    v_mul_f32 v73, s33, v73
    v_mul_f32 v74, s33, v74
    v_mul_f32 v75, s33, v75
    v_cvt_pk_bf16_f32 v76, v72, v73
    v_cvt_pk_bf16_f32 v77, v74, v75
    s_and_saveexec_b64 s[40:41], vcc
    buffer_store_dwordx2 v[76:77], v7, s[36:39], s32 offen
    s_endpgm
PREP_END:
    s_endpgm
.globl gather_scatter__graph_attention_gat__graph_kernel
.p2align 8
.type gather_scatter__graph_attention_gat__graph_kernel,@function
gather_scatter__graph_attention_gat__graph_kernel:
    s_cmp_ge_u32 s2, 250
    s_cbranch_scc1 MAIN_END
    s_load_dwordx2 s[60:61], s[0:1], 64
    s_load_dwordx2 s[52:53], s[0:1], 0
    s_load_dwordx2 s[54:55], s[0:1], 48
    s_load_dwordx4 s[56:59], s[0:1], 8
    v_and_b32 v38, 63, v0
    v_lshrrev_b32 v42, 6, v0
    v_and_b32 v36, 15, v38
    v_readfirstlane_b32 s24, v42
    v_lshrrev_b32 v37, 4, v38
    v_lshlrev_b32 v20, 4, v0
    v_lshlrev_b32 v45, 4, v38
    v_lshlrev_b32 v21, 9, v36
    v_lshl_add_u32 v21, v37, 4, v21
    s_mul_i32 s45, s24, 17408
    s_and_b32 s47, s2, 0
    s_lshl_b32 s47, s47, 19
    s_lshl_b32 s41, s24, 16
    s_add_u32 s47, s47, s41
    s_add_u32 s47, s47, 2097152
    s_waitcnt lgkmcnt(0)
    s_mov_b32 s8, s60
    s_mov_b32 s9, s61
    s_mov_b32 s10, 2621440
    s_mov_b32 s11, 0x00020000
    s_lshl_b32 s41, s2, 13
    buffer_load_dwordx4 v[16:19], v20, s[8:11], s41 offen
    s_mov_b32 s4, s52
    s_mov_b32 s5, s53
    s_mov_b32 s6, 5120000
    s_mov_b32 s7, 0x00020000
    s_cmp_ge_u32 s24, 4
    s_cbranch_scc1 MAIN_NOV
    s_lshl_b32 s41, s24, 10
    s_add_u32 s41, s41, 2064384
    buffer_load_dwordx4 v[24:27], v45, s[8:11], s41 offen
MAIN_NOV:
    v_and_b32 v42, 31, v38
    v_lshlrev_b32 v42, 4, v42
    v_lshrrev_b32 v43, 5, v38
    v_lshlrev_b32 v6, 2, v43
    v_lshlrev_b32 v21, 9, v43
    v_cmp_eq_u32 vcc, 0, v43
    v_lshlrev_b32 v43, 5, v43
    v_xor_b32 v1, v42, v43
    v_add_u32 v21, v21, v1
    v_mov_b32 v22, 0x7ffffe00
    v_cndmask_b32 v22, v22, v1, vcc
    s_mul_i32 s41, s2, 20480
    s_lshl_b32 s42, s24, 11
    s_add_u32 s42, s42, s41
    s_add_u32 m0, s45, 8704
    s_add_u32 s43, s42, 1024
    buffer_load_dwordx4 v21, s[4:7], s42 offen lds
    s_add_u32 m0, s45, 9792
    s_lshl_b32 s42, s24, 9
    buffer_load_dwordx4 v21, s[4:7], s43 offen lds
    s_add_u32 m0, s45, 10880
    s_add_u32 s42, s42, s41
    s_add_u32 s42, s42, 16384
    buffer_load_dwordx4 v22, s[4:7], s42 offen lds
    s_mov_b32 s12, s54
    s_mov_b32 s13, s55
    s_mov_b32 s14, 5120000
    s_mov_b32 s15, 0x00020000
    s_mov_b32 s16, s56
    s_mov_b32 s17, s57
    s_mov_b32 s18, 640000
    s_mov_b32 s19, 0x00020000
    s_mov_b32 s20, s58
    s_mov_b32 s21, s59
    s_mov_b32 s22, 640000
    s_mov_b32 s23, 0x00020000
    v_mov_b32 v28, 0x7ffffe3f
    v_mov_b32 v29, v28
    v_mov_b32 v30, v28
    v_mov_b32 v31, v28
    v_add_u32 v22, 155904, v20
    v_cmp_gt_u32 vcc, 352, v0
    v_mov_b32 v32, 0
    v_lshlrev_b32 v23, 2, v0
    v_add_u32 v23, 162304, v23
    s_and_saveexec_b64 s[48:49], vcc
    s_cbranch_execz MAIN_NOCNT
    ds_write_b128 v22, v[28:31]
    v_cmp_gt_u32 vcc, 32, v0
    s_and_b64 exec, exec, vcc
    s_cbranch_execz MAIN_NOCNT
    ds_write_b32 v23, v32
MAIN_NOCNT:
    s_mov_b64 exec, s[48:49]
    v_lshlrev_b32 v5, 4, v37
    v_lshrrev_b32 v42, 1, v36
    v_mul_u32_u24 v2, 1088, v42
    v_and_b32 v42, 1, v36
    v_lshl_add_u32 v2, v42, 9, v2
    v_lshrrev_b32 v43, 1, v37
    v_xor_b32 v42, v42, v43
    v_lshl_add_u32 v2, v42, 5, v2
    v_and_b32 v42, 1, v37
    v_lshl_add_u32 v2, v42, 4, v2
    v_add_u32 v2, s45, v2
    v_lshrrev_b32 v42, 2, v36
    v_lshl_add_u32 v42, v37, 2, v42
    v_lshrrev_b32 v43, 1, v42
    v_mul_u32_u24 v3, 1088, v43
    v_and_b32 v42, 1, v42
    v_lshl_add_u32 v3, v42, 9, v3
    v_and_b32 v43, 3, v36
    v_lshl_add_u32 v3, v43, 3, v3
    v_add_u32 v3, s45, v3
    v_lshlrev_b32 v42, 5, v42
    v_sub_u32 v4, v3, v42
    v_add_u32 v3, v3, v42
    v_mov_b32 v224, 0x3f803f80
    v_mov_b32 v225, 0x3f803f80
    v_mov_b32 v226, 0x3f803f80
    v_mov_b32 v227, 0x3f803f80
    s_mov_b32 s40, 0xfffffe00
    s_mov_b32 s50, 0x3e4ccccd
    s_mul_i32 s44, s24, 704
    s_add_u32 s44, s44, 156096
    s_mul_i32 s41, s24, 2080
    s_add_u32 s41, s41, 139264
    v_lshrrev_b32 v46, 2, v36
    v_lshlrev_b32 v46, 7, v46
    v_add_u32 v46, s41, v46
    v_and_b32 v42, 3, v36
    v_lshl_add_u32 v46, v42, 9, v46
    v_and_b32 v43, 1, v42
    v_xor_b32 v43, v43, v37
    v_lshl_add_u32 v46, v43, 4, v46
    v_lshrrev_b32 v42, 1, v42
    v_lshlrev_b32 v42, 6, v42
    v_sub_u32 v47, v46, v42
    v_add_u32 v46, v46, v42
    v_and_b32 v42, 3, v36
    v_mul_u32_u24 v39, 576, v42
    v_lshl_add_u32 v39, v37, 4, v39
    v_add_u32 v39, 139264, v39
    v_lshrrev_b32 v42, 5, v38
    s_lshl_b32 s41, s24, 1
    v_add_u32 v42, s41, v42
    v_mul_u32_u24 v22, 576, v42
    v_and_b32 v42, 31, v38
    v_lshl_add_u32 v22, v42, 4, v22
    v_add_u32 v22, 139264, v22
    v_lshrrev_b32 v42, 2, v36
    s_lshl_b32 s41, s24, 2
    v_add_u32 v40, s41, v42
    s_add_u32 s41, s24, 32
    v_mov_b32 v7, s41
    s_waitcnt vmcnt(3)
    s_cmp_ge_u32 s24, 4
    s_cbranch_scc1 MAIN_WB
    ds_write_b128 v22, v[24:27]
MAIN_WB:
    s_mov_b64 s[62:63], 0
    v_and_b32 v20, 63, v16
    v_cmp_eq_u32 vcc, -2, v16
    s_or_b64 s[62:63], s[62:63], vcc
    v_cmp_gt_u32 s[64:65], 40, v20
    v_cmp_le_u32 s[72:73], 32, v20
    v_lshrrev_b32 v42, 2, v20
    v_subrev_u32 v43, 32, v20
    v_subrev_u32 v44, 24, v20
    v_cndmask_b32 v24, v42, v43, s[72:73]
    v_cndmask_b32 v42, v42, v44, s[72:73]
    v_lshlrev_b32 v32, 2, v42
    v_add_u32 v32, 162304, v32
    v_and_b32 v21, 63, v17
    v_cmp_eq_u32 vcc, -2, v17
    s_or_b64 s[62:63], s[62:63], vcc
    v_cmp_gt_u32 s[66:67], 40, v21
    v_cmp_le_u32 s[74:75], 32, v21
    v_lshrrev_b32 v42, 2, v21
    v_subrev_u32 v43, 32, v21
    v_subrev_u32 v44, 24, v21
    v_cndmask_b32 v25, v42, v43, s[74:75]
    v_cndmask_b32 v42, v42, v44, s[74:75]
    v_lshlrev_b32 v33, 2, v42
    v_add_u32 v33, 162304, v33
    v_and_b32 v22, 63, v18
    v_cmp_eq_u32 vcc, -2, v18
    s_or_b64 s[62:63], s[62:63], vcc
    v_cmp_gt_u32 s[68:69], 40, v22
    v_cmp_le_u32 s[76:77], 32, v22
    v_lshrrev_b32 v42, 2, v22
    v_subrev_u32 v43, 32, v22
    v_subrev_u32 v44, 24, v22
    v_cndmask_b32 v26, v42, v43, s[76:77]
    v_cndmask_b32 v42, v42, v44, s[76:77]
    v_lshlrev_b32 v34, 2, v42
    v_add_u32 v34, 162304, v34
    v_and_b32 v23, 63, v19
    v_cmp_eq_u32 vcc, -2, v19
    s_or_b64 s[62:63], s[62:63], vcc
    v_cmp_gt_u32 s[70:71], 40, v23
    v_cmp_le_u32 s[78:79], 32, v23
    v_lshrrev_b32 v42, 2, v23
    v_subrev_u32 v43, 32, v23
    v_subrev_u32 v44, 24, v23
    v_cndmask_b32 v27, v42, v43, s[78:79]
    v_cndmask_b32 v42, v42, v44, s[78:79]
    v_lshlrev_b32 v35, 2, v42
    v_add_u32 v35, 162304, v35
    v_mov_b32 v0, 1
    s_waitcnt lgkmcnt(0)
    s_barrier
    s_mov_b64 exec, s[64:65]
    ds_add_rtn_u32 v28, v32, v0
    s_mov_b64 exec, s[66:67]
    ds_add_rtn_u32 v29, v33, v0
    s_mov_b64 exec, s[68:69]
    ds_add_rtn_u32 v30, v34, v0
    s_mov_b64 exec, s[70:71]
    ds_add_rtn_u32 v31, v35, v0
    s_mov_b64 exec, -1
    s_mov_b32 s41, 704
    v_mov_b32 v42, 156096
    v_mad_u32_u24 v32, v24, s41, v42
    v_mad_u32_u24 v33, v25, s41, v42
    v_mad_u32_u24 v34, v26, s41, v42
    v_mad_u32_u24 v35, v27, s41, v42
    s_waitcnt lgkmcnt(3)
    v_lshlrev_b32 v42, 2, v28
    v_sub_u32 v43, -4, v42
    v_mov_b32 v44, 128
    v_cndmask_b32 v42, v42, v43, s[72:73]
    v_cndmask_b32 v44, v44, 48, s[72:73]
    v_add_u32 v32, v32, v42
    v_cmp_lt_u32 vcc, v28, v44
    s_andn2_b64 s[80:81], s[64:65], vcc
    s_or_b64 s[62:63], s[62:63], s[80:81]
    s_and_b64 exec, s[64:65], vcc
    ds_write_b32 v32, v16
    s_mov_b64 exec, -1
    s_waitcnt lgkmcnt(2)
    v_lshlrev_b32 v42, 2, v29
    v_sub_u32 v43, -4, v42
    v_mov_b32 v44, 128
    v_cndmask_b32 v42, v42, v43, s[74:75]
    v_cndmask_b32 v44, v44, 48, s[74:75]
    v_add_u32 v33, v33, v42
    v_cmp_lt_u32 vcc, v29, v44
    s_andn2_b64 s[80:81], s[66:67], vcc
    s_or_b64 s[62:63], s[62:63], s[80:81]
    s_and_b64 exec, s[66:67], vcc
    ds_write_b32 v33, v17
    s_mov_b64 exec, -1
    s_waitcnt lgkmcnt(1)
    v_lshlrev_b32 v42, 2, v30
    v_sub_u32 v43, -4, v42
    v_mov_b32 v44, 128
    v_cndmask_b32 v42, v42, v43, s[76:77]
    v_cndmask_b32 v44, v44, 48, s[76:77]
    v_add_u32 v34, v34, v42
    v_cmp_lt_u32 vcc, v30, v44
    s_andn2_b64 s[80:81], s[68:69], vcc
    s_or_b64 s[62:63], s[62:63], s[80:81]
    s_and_b64 exec, s[68:69], vcc
    ds_write_b32 v34, v18
    s_mov_b64 exec, -1
    s_waitcnt lgkmcnt(0)
    v_lshlrev_b32 v42, 2, v31
    v_sub_u32 v43, -4, v42
    v_mov_b32 v44, 128
    v_cndmask_b32 v42, v42, v43, s[78:79]
    v_cndmask_b32 v44, v44, 48, s[78:79]
    v_add_u32 v35, v35, v42
    v_cmp_lt_u32 vcc, v31, v44
    s_andn2_b64 s[80:81], s[70:71], vcc
    s_or_b64 s[62:63], s[62:63], s[80:81]
    s_and_b64 exec, s[70:71], vcc
    ds_write_b32 v35, v19
    s_mov_b64 exec, -1
    s_cmp_eq_u64 s[62:63], 0
    s_cbranch_scc1 MAIN_NOOVF
    v_mov_b32 v42, 162368
    ds_write_b32 v42, v0
MAIN_NOOVF:
    s_waitcnt lgkmcnt(0)
    s_barrier
    s_lshl_b32 s41, s24, 2
    s_add_u32 s41, s41, 162304
    v_mov_b32 v16, s41
    v_mov_b32 v17, 162368
    ds_read_b32 v18, v16
    ds_read_b32 v19, v16 offset:32
    ds_read_b32 v20, v17
    v_lshrrev_b32 v42, 2, v36
    v_cmp_eq_u32 s[70:71], 1, v42
    v_cmp_eq_u32 s[72:73], 2, v42
    v_cmp_eq_u32 s[74:75], 3, v42
    s_waitcnt lgkmcnt(0)
    v_readfirstlane_b32 s25, v18
    v_readfirstlane_b32 s26, v19
    v_readfirstlane_b32 s41, v20
    s_mov_b32 s30, s45
    s_mov_b32 s31, 8704
    s_mov_b32 s28, 0
    s_mov_b32 s52, 1
    s_cmp_lg_u32 s41, 0
    s_cbranch_scc1 MAIN_SLOW
    s_sub_u32 s54, s25, 1
    s_and_b32 s54, s54, 15
    s_lshr_b32 s54, s54, 1
    s_add_u32 s54, s54, 1
    s_sub_u32 s55, s26, 1
    s_and_b32 s55, s55, 15
    s_lshr_b32 s55, s55, 1
    s_add_u32 s55, s55, 1
    s_cmp_eq_u32 s25, 0
    s_cselect_b32 s54, 8, s54
    s_add_u32 s25, s25, 15
    s_lshr_b32 s25, s25, 4
    s_add_u32 s26, s26, 15
    s_lshr_b32 s26, s26, 4
    s_add_u32 s27, s25, s26
    s_lshl_b32 s41, s26, 6
    s_sub_u32 s29, s44, s41
    s_setprio 3
    s_mov_b32 s53, 0
    s_cmp_eq_u32 s27, 0
    s_cbranch_scc1 MAIN_PRO_T
    v_add_u32 v42, s29, v6
    ds_read2_b32 v[20:21], v42 offset0:0 offset1:2
    ds_read2_b32 v[22:23], v42 offset0:4 offset1:6
    ds_read2_b32 v[24:25], v42 offset0:8 offset1:10
    ds_read2_b32 v[26:27], v42 offset0:12 offset1:14
    s_mov_b32 s42, 0
    s_waitcnt lgkmcnt(0)
    s_mov_b32 s53, 8
    s_mov_b32 m0, s30
    v_and_or_b32 v20, v20, s40, v1
    buffer_load_dwordx4 v20, s[4:7], 0 offen lds
    s_add_u32 m0, s30, 1088
    v_and_or_b32 v21, v21, s40, v1
    buffer_load_dwordx4 v21, s[4:7], 0 offen lds
    s_add_u32 m0, s30, 2176
    v_and_or_b32 v22, v22, s40, v1
    buffer_load_dwordx4 v22, s[4:7], 0 offen lds
    s_add_u32 m0, s30, 3264
    v_and_or_b32 v23, v23, s40, v1
    buffer_load_dwordx4 v23, s[4:7], 0 offen lds
    s_add_u32 m0, s30, 4352
    v_and_or_b32 v24, v24, s40, v1
    buffer_load_dwordx4 v24, s[4:7], 0 offen lds
    s_add_u32 m0, s30, 5440
    v_and_or_b32 v25, v25, s40, v1
    buffer_load_dwordx4 v25, s[4:7], 0 offen lds
    s_add_u32 m0, s30, 6528
    v_and_or_b32 v26, v26, s40, v1
    buffer_load_dwordx4 v26, s[4:7], 0 offen lds
    s_add_u32 m0, s30, 7616
    v_and_or_b32 v27, v27, s40, v1
    buffer_load_dwordx4 v27, s[4:7], 0 offen lds
MAIN_PRO_T:
    ds_read_b128 v[160:163], v39 offset:2304
    ds_read_b128 v[164:167], v39 offset:2368
    ds_read_b128 v[168:171], v39 offset:2432
    ds_read_b128 v[172:175], v39 offset:2496
    ds_read_b128 v[176:179], v39 offset:2560
    ds_read_b128 v[180:183], v39 offset:2624
    ds_read_b128 v[184:187], v39 offset:2688
    ds_read_b128 v[188:191], v39 offset:2752
    ds_read_b128 v[128:131], v39 offset:0
    ds_read_b128 v[132:135], v39 offset:64
    ds_read_b128 v[136:139], v39 offset:128
    ds_read_b128 v[140:143], v39 offset:192
    ds_read_b128 v[144:147], v39 offset:256
    ds_read_b128 v[148:151], v39 offset:320
    ds_read_b128 v[152:155], v39 offset:384
    ds_read_b128 v[156:159], v39 offset:448
    s_waitcnt lgkmcnt(0)
    s_barrier
    s_cmp_ge_u32 s53, 4
    s_cbranch_scc1 WV_2
    s_cmp_ge_u32 s53, 2
    s_cbranch_scc1 WV_3
    s_cmp_ge_u32 s53, 1
    s_cbranch_scc1 WV_4
    s_waitcnt vmcnt(0)
    s_branch WV_1
WV_4:
    s_waitcnt vmcnt(1)
    s_branch WV_1
WV_3:
    s_cmp_ge_u32 s53, 3
    s_cbranch_scc1 WV_5
    s_waitcnt vmcnt(2)
    s_branch WV_1
WV_5:
    s_waitcnt vmcnt(3)
    s_branch WV_1
WV_2:
    s_cmp_ge_u32 s53, 6
    s_cbranch_scc1 WV_6
    s_cmp_ge_u32 s53, 5
    s_cbranch_scc1 WV_7
    s_waitcnt vmcnt(4)
    s_branch WV_1
WV_7:
    s_waitcnt vmcnt(5)
    s_branch WV_1
WV_6:
    s_cmp_ge_u32 s53, 7
    s_cbranch_scc1 WV_8
    s_waitcnt vmcnt(6)
    s_branch WV_1
WV_8:
    s_cmp_ge_u32 s53, 8
    s_cbranch_scc1 WV_9
    s_waitcnt vmcnt(7)
    s_branch WV_1
WV_9:
    s_waitcnt vmcnt(8)
    s_branch WV_1
WV_1:
    ds_read_b128 v[64:67], v2 offset:8704
    ds_read_b128 v[68:71], v2 offset:8768
    ds_read_b128 v[72:75], v2 offset:8832
    ds_read_b128 v[76:79], v2 offset:8896
    ds_read_b128 v[80:83], v2 offset:8960
    ds_read_b128 v[84:87], v2 offset:9024
    ds_read_b128 v[88:91], v2 offset:9088
    ds_read_b128 v[92:95], v2 offset:9152
    v_lshlrev_b32 v43, 2, v36
    v_and_b32 v44, 3, v36
    v_add_u32 v44, 16, v44
    v_lshlrev_b32 v44, 2, v44
    s_waitcnt lgkmcnt(7)
    v_mfma_f32_16x16x32_bf16 v[28:31], v[64:67], v[160:163], 0
    s_waitcnt lgkmcnt(6)
    v_mfma_f32_16x16x32_bf16 v[28:31], v[68:71], v[164:167], v[28:31]
    s_waitcnt lgkmcnt(5)
    v_mfma_f32_16x16x32_bf16 v[28:31], v[72:75], v[168:171], v[28:31]
    s_waitcnt lgkmcnt(4)
    v_mfma_f32_16x16x32_bf16 v[28:31], v[76:79], v[172:175], v[28:31]
    s_waitcnt lgkmcnt(3)
    v_mfma_f32_16x16x32_bf16 v[28:31], v[80:83], v[176:179], v[28:31]
    s_waitcnt lgkmcnt(2)
    v_mfma_f32_16x16x32_bf16 v[28:31], v[84:87], v[180:183], v[28:31]
    s_waitcnt lgkmcnt(1)
    v_mfma_f32_16x16x32_bf16 v[28:31], v[88:91], v[184:187], v[28:31]
    s_waitcnt lgkmcnt(0)
    v_mfma_f32_16x16x32_bf16 v[28:31], v[92:95], v[188:191], v[28:31]
    s_nop 7
    v_cndmask_b32 v41, v28, v29, s[70:71]
    v_cndmask_b32 v41, v41, v30, s[72:73]
    v_cndmask_b32 v41, v41, v31, s[74:75]
    ds_bpermute_b32 v8, v44, v28
    ds_bpermute_b32 v41, v43, v41
    s_waitcnt lgkmcnt(0)
    v_mov_b32 v9, v8
    v_mov_b32 v10, v8
    v_mov_b32 v11, v8
    s_mov_b32 s53, 0
    s_cmp_le_u32 s27, 1
    s_cbranch_scc1 MAIN_PRO_DONE
    v_add_u32 v42, s29, v6
    v_add_u32 v42, 64, v42
    ds_read2_b32 v[20:21], v42 offset0:0 offset1:2
    ds_read2_b32 v[22:23], v42 offset0:4 offset1:6
    ds_read2_b32 v[24:25], v42 offset0:8 offset1:10
    ds_read2_b32 v[26:27], v42 offset0:12 offset1:14
    s_add_u32 s30, s45, 8704
    s_mov_b32 s42, 1
    s_mov_b32 s53, 8
    s_waitcnt lgkmcnt(0)
    s_mov_b32 m0, s30
    v_and_or_b32 v20, v20, s40, v1
    buffer_load_dwordx4 v20, s[4:7], 0 offen lds
    s_add_u32 m0, s30, 1088
    v_and_or_b32 v21, v21, s40, v1
    buffer_load_dwordx4 v21, s[4:7], 0 offen lds
    s_add_u32 m0, s30, 2176
    v_and_or_b32 v22, v22, s40, v1
    buffer_load_dwordx4 v22, s[4:7], 0 offen lds
    s_add_u32 m0, s30, 3264
    v_and_or_b32 v23, v23, s40, v1
    buffer_load_dwordx4 v23, s[4:7], 0 offen lds
    s_add_u32 m0, s30, 4352
    v_and_or_b32 v24, v24, s40, v1
    buffer_load_dwordx4 v24, s[4:7], 0 offen lds
    s_add_u32 m0, s30, 5440
    v_and_or_b32 v25, v25, s40, v1
    buffer_load_dwordx4 v25, s[4:7], 0 offen lds
    s_add_u32 m0, s30, 6528
    v_and_or_b32 v26, v26, s40, v1
    buffer_load_dwordx4 v26, s[4:7], 0 offen lds
    s_add_u32 m0, s30, 7616
    v_and_or_b32 v27, v27, s40, v1
    buffer_load_dwordx4 v27, s[4:7], 0 offen lds
    s_mov_b32 s30, s45
MAIN_PRO_DONE:
    s_add_u32 s41, s47, 0
    buffer_load_dwordx4 v[232:235], v45, s[8:11], s41 offen
    buffer_load_dwordx4 v[236:239], v45, s[8:11], s41 offen offset:1024
    s_add_u32 s41, s47, 2048
    buffer_load_dwordx4 v[240:243], v45, s[8:11], s41 offen
    buffer_load_dwordx4 v[244:247], v45, s[8:11], s41 offen offset:1024
    s_cmp_eq_u32 s27, 0
    s_cbranch_scc1 MAIN_LOOP
    s_cmp_ge_u32 s53, 4
    s_cbranch_scc1 WV_11
    s_cmp_ge_u32 s53, 2
    s_cbranch_scc1 WV_12
    s_cmp_ge_u32 s53, 1
    s_cbranch_scc1 WV_13
    s_waitcnt vmcnt(4)
    s_branch WV_10
WV_13:
    s_waitcnt vmcnt(5)
    s_branch WV_10
WV_12:
    s_cmp_ge_u32 s53, 3
    s_cbranch_scc1 WV_14
    s_waitcnt vmcnt(6)
    s_branch WV_10
WV_14:
    s_waitcnt vmcnt(7)
    s_branch WV_10
WV_11:
    s_cmp_ge_u32 s53, 6
    s_cbranch_scc1 WV_15
    s_cmp_ge_u32 s53, 5
    s_cbranch_scc1 WV_16
    s_waitcnt vmcnt(8)
    s_branch WV_10
WV_16:
    s_waitcnt vmcnt(9)
    s_branch WV_10
WV_15:
    s_cmp_ge_u32 s53, 7
    s_cbranch_scc1 WV_17
    s_waitcnt vmcnt(10)
    s_branch WV_10
WV_17:
    s_cmp_ge_u32 s53, 8
    s_cbranch_scc1 WV_18
    s_waitcnt vmcnt(11)
    s_branch WV_10
WV_18:
    s_waitcnt vmcnt(12)
    s_branch WV_10
WV_10:
    s_waitcnt lgkmcnt(0)
    v_add_u32 v0, s29, v5
    ds_read_b128 v[16:19], v0
    ds_read_b128 v[48:51], v2 offset:0
    ds_read_b128 v[52:55], v2 offset:64
    ds_read_b128 v[56:59], v2 offset:128
    ds_read_b128 v[60:63], v2 offset:192
MAIN_LOOP:
    s_cmp_eq_u32 s28, s26
    s_cbranch_scc1 MAIN_FINB
MAIN_LOOP2:
    s_cmp_ge_u32 s28, s27
    s_cbranch_scc1 MAIN_DONE
    s_add_u32 s46, s29, 128
    s_cmp_ge_u32 s28, 2
    s_cbranch_scc1 PR_19
    s_setprio 3
    s_branch PR_21
PR_19:
    s_cmp_ge_u32 s28, 4
    s_cbranch_scc1 PR_20
    s_setprio 2
    s_branch PR_21
PR_20:
    s_setprio 1
PR_21:
    v_add_u32 v42, s46, v6
    s_waitcnt lgkmcnt(3)
    v_mfma_f32_16x16x32_bf16 v[28:31], v[48:51], v[128:131], v[8:11]
    ds_read_b128 v[48:51], v2 offset:256
    ds_read_b64_tr_b16 v[64:65], v3 offset:0
    ds_read_b64_tr_b16 v[68:69], v4 offset:32
    ds_read_b64_tr_b16 v[72:73], v3 offset:64
    ds_read_b64_tr_b16 v[76:77], v4 offset:96
    s_waitcnt lgkmcnt(7)
    v_mfma_f32_16x16x32_bf16 v[28:31], v[52:55], v[132:135], v[28:31]
    ds_read_b128 v[52:55], v2 offset:320
    ds_read_b64_tr_b16 v[80:81], v3 offset:128
    ds_read_b64_tr_b16 v[84:85], v4 offset:160
    ds_read_b64_tr_b16 v[88:89], v3 offset:192
    ds_read_b64_tr_b16 v[92:93], v4 offset:224
    s_waitcnt lgkmcnt(11)
    v_mfma_f32_16x16x32_bf16 v[28:31], v[56:59], v[136:139], v[28:31]
    ds_read_b128 v[56:59], v2 offset:384
    ds_read_b64_tr_b16 v[96:97], v3 offset:256
    ds_read_b64_tr_b16 v[100:101], v4 offset:288
    ds_read_b64_tr_b16 v[104:105], v3 offset:320
    ds_read_b64_tr_b16 v[108:109], v4 offset:352
    s_waitcnt lgkmcnt(14)
    v_mfma_f32_16x16x32_bf16 v[28:31], v[60:63], v[140:143], v[28:31]
    ds_read_b128 v[60:63], v2 offset:448
    ds_read_b64_tr_b16 v[112:113], v3 offset:384
    ds_read_b64_tr_b16 v[116:117], v4 offset:416
    ds_read_b64_tr_b16 v[120:121], v3 offset:448
    ds_read_b64_tr_b16 v[124:125], v4 offset:480
    ds_read2_b32 v[20:21], v42 offset0:0 offset1:2
    ds_read2_b32 v[22:23], v42 offset0:4 offset1:6
    ds_read2_b32 v[24:25], v42 offset0:8 offset1:10
    ds_read2_b32 v[26:27], v42 offset0:12 offset1:14
    s_waitcnt lgkmcnt(14)
    v_mfma_f32_16x16x32_bf16 v[28:31], v[48:51], v[144:147], v[28:31]
    s_waitcnt lgkmcnt(14)
    v_mfma_f32_16x16x32_bf16 v[28:31], v[52:55], v[148:151], v[28:31]
    s_waitcnt lgkmcnt(13)
    v_mfma_f32_16x16x32_bf16 v[28:31], v[56:59], v[152:155], v[28:31]
    s_sub_u32 s41, s27, s28
    s_add_u32 s42, s28, 1
    s_cmp_eq_u32 s42, s26
    s_cbranch_scc1 TL_LAST
    s_cmp_eq_u32 s42, s27
    s_cbranch_scc1 TL_LAST
    s_cmp_ge_u32 s41, 3
    s_cbranch_scc0 TE_0_R2
    s_waitcnt lgkmcnt(0)
    v_mfma_f32_16x16x32_bf16 v[28:31], v[60:63], v[156:159], v[28:31]
    s_mov_b32 m0, s30
    v_and_or_b32 v20, v20, s40, v1
    buffer_load_dwordx4 v20, s[4:7], 0 offen lds
    s_add_u32 m0, s30, 1088
    v_and_or_b32 v21, v21, s40, v1
    buffer_load_dwordx4 v21, s[4:7], 0 offen lds
    v_cmp_eq_u32_sdwa s[32:33], v16, v7 src0_sel:BYTE_0 src1_sel:DWORD
    v_cmp_eq_u32_sdwa s[34:35], v17, v7 src0_sel:BYTE_0 src1_sel:DWORD
    v_cmp_eq_u32_sdwa s[36:37], v18, v7 src0_sel:BYTE_0 src1_sel:DWORD
    v_cmp_eq_u32_sdwa s[38:39], v19, v7 src0_sel:BYTE_0 src1_sel:DWORD
    v_pk_mul_f32 v[36:37], v[28:29], s[50:51] op_sel_hi:[1,0]
    v_pk_mul_f32 v[38:39], v[30:31], s[50:51] op_sel_hi:[1,0]
    s_add_u32 m0, s30, 2176
    v_and_or_b32 v22, v22, s40, v1
    buffer_load_dwordx4 v22, s[4:7], 0 offen lds
    v_max_f32 v36, v36, v28
    v_max_f32 v37, v37, v29
    v_max_f32 v38, v38, v30
    v_max_f32 v39, v39, v31
    s_add_u32 m0, s30, 3264
    v_and_or_b32 v23, v23, s40, v1
    buffer_load_dwordx4 v23, s[4:7], 0 offen lds
    v_exp_f32 v36, v36
    v_exp_f32 v37, v37
    v_exp_f32 v38, v38
    v_exp_f32 v39, v39
    s_add_u32 m0, s30, 4352
    v_and_or_b32 v24, v24, s40, v1
    buffer_load_dwordx4 v24, s[4:7], 0 offen lds
    v_cndmask_b32 v36, 0, v36, s[32:33]
    v_cndmask_b32 v37, 0, v37, s[34:35]
    v_cndmask_b32 v38, 0, v38, s[36:37]
    v_cndmask_b32 v39, 0, v39, s[38:39]
    s_add_u32 m0, s30, 5440
    v_and_or_b32 v25, v25, s40, v1
    buffer_load_dwordx4 v25, s[4:7], 0 offen lds
    v_cvt_pk_bf16_f32 v12, v36, v37
    v_cvt_pk_bf16_f32 v13, v38, v39
    s_add_u32 m0, s30, 6528
    v_and_or_b32 v26, v26, s40, v1
    buffer_load_dwordx4 v26, s[4:7], 0 offen lds
    s_add_u32 m0, s30, 7616
    v_and_or_b32 v27, v27, s40, v1
    buffer_load_dwordx4 v27, s[4:7], 0 offen lds
    v_add_u32 v2, s31, v2
    s_add_u32 s29, s29, 64
    s_waitcnt vmcnt(8)
    v_add_u32 v0, s29, v5
    ds_read_b128 v[16:19], v0
    ds_read_b128 v[48:51], v2 offset:0
    ds_read_b128 v[52:55], v2 offset:64
    ds_read_b128 v[56:59], v2 offset:128
    ds_read_b128 v[60:63], v2 offset:192
    v_add_u32 v3, s31, v3
    v_add_u32 v4, s31, v4
    s_add_u32 s30, s30, s31
    s_sub_u32 s31, 0, s31
    s_add_u32 s28, s28, 1
    s_branch MAIN_ODD
TE_0_R2:
    s_waitcnt lgkmcnt(0)
    v_mfma_f32_16x16x32_bf16 v[28:31], v[60:63], v[156:159], v[28:31]
    v_cmp_eq_u32_sdwa s[32:33], v16, v7 src0_sel:BYTE_0 src1_sel:DWORD
    v_cmp_eq_u32_sdwa s[34:35], v17, v7 src0_sel:BYTE_0 src1_sel:DWORD
    v_cmp_eq_u32_sdwa s[36:37], v18, v7 src0_sel:BYTE_0 src1_sel:DWORD
    v_cmp_eq_u32_sdwa s[38:39], v19, v7 src0_sel:BYTE_0 src1_sel:DWORD
    s_nop 3
    v_pk_mul_f32 v[36:37], v[28:29], s[50:51] op_sel_hi:[1,0]
    v_pk_mul_f32 v[38:39], v[30:31], s[50:51] op_sel_hi:[1,0]
    v_max_f32 v36, v36, v28
    v_max_f32 v37, v37, v29
    v_max_f32 v38, v38, v30
    v_max_f32 v39, v39, v31
    v_exp_f32 v36, v36
    v_exp_f32 v37, v37
    v_exp_f32 v38, v38
    v_exp_f32 v39, v39
    v_cndmask_b32 v36, 0, v36, s[32:33]
    v_cndmask_b32 v37, 0, v37, s[34:35]
    v_cndmask_b32 v38, 0, v38, s[36:37]
    v_cndmask_b32 v39, 0, v39, s[38:39]
    v_cvt_pk_bf16_f32 v12, v36, v37
    v_cvt_pk_bf16_f32 v13, v38, v39
    s_nop 1
    v_add_u32 v2, s31, v2
    s_add_u32 s29, s29, 64
    s_waitcnt vmcnt(0)
    v_add_u32 v0, s29, v5
    ds_read_b128 v[16:19], v0
    ds_read_b128 v[48:51], v2 offset:0
    ds_read_b128 v[52:55], v2 offset:64
    ds_read_b128 v[56:59], v2 offset:128
    ds_read_b128 v[60:63], v2 offset:192
    v_add_u32 v3, s31, v3
    v_add_u32 v4, s31, v4
    s_add_u32 s30, s30, s31
    s_sub_u32 s31, 0, s31
    s_add_u32 s28, s28, 1
    s_branch MAIN_ODD
TL_LAST:
    s_cmp_eq_u32 s52, 0
    s_cbranch_scc0 TL_F1
    s_cmp_ge_u32 s41, 3
    s_cbranch_scc0 TL_0_R2
    s_waitcnt lgkmcnt(0)
    v_mfma_f32_16x16x32_bf16 v[28:31], v[60:63], v[156:159], v[28:31]
    s_mov_b32 m0, s30
    v_and_or_b32 v20, v20, s40, v1
    buffer_load_dwordx4 v20, s[4:7], 0 offen lds
    s_add_u32 m0, s30, 1088
    v_and_or_b32 v21, v21, s40, v1
    buffer_load_dwordx4 v21, s[4:7], 0 offen lds
    v_cmp_eq_u32_sdwa s[32:33], v16, v7 src0_sel:BYTE_0 src1_sel:DWORD
    v_cmp_eq_u32_sdwa s[34:35], v17, v7 src0_sel:BYTE_0 src1_sel:DWORD
    v_cmp_eq_u32_sdwa s[36:37], v18, v7 src0_sel:BYTE_0 src1_sel:DWORD
    v_cmp_eq_u32_sdwa s[38:39], v19, v7 src0_sel:BYTE_0 src1_sel:DWORD
    v_pk_mul_f32 v[36:37], v[28:29], s[50:51] op_sel_hi:[1,0]
    v_pk_mul_f32 v[38:39], v[30:31], s[50:51] op_sel_hi:[1,0]
    s_add_u32 m0, s30, 2176
    v_and_or_b32 v22, v22, s40, v1
    buffer_load_dwordx4 v22, s[4:7], 0 offen lds
    v_max_f32 v36, v36, v28
    v_max_f32 v37, v37, v29
    v_max_f32 v38, v38, v30
    v_max_f32 v39, v39, v31
    s_add_u32 m0, s30, 3264
    v_and_or_b32 v23, v23, s40, v1
    buffer_load_dwordx4 v23, s[4:7], 0 offen lds
    v_exp_f32 v36, v36
    v_exp_f32 v37, v37
    v_exp_f32 v38, v38
    v_exp_f32 v39, v39
    s_add_u32 m0, s30, 4352
    v_and_or_b32 v24, v24, s40, v1
    buffer_load_dwordx4 v24, s[4:7], 0 offen lds
    v_cndmask_b32 v36, 0, v36, s[32:33]
    v_cndmask_b32 v37, 0, v37, s[34:35]
    v_cndmask_b32 v38, 0, v38, s[36:37]
    v_cndmask_b32 v39, 0, v39, s[38:39]
    s_add_u32 m0, s30, 5440
    v_and_or_b32 v25, v25, s40, v1
    buffer_load_dwordx4 v25, s[4:7], 0 offen lds
    v_cvt_pk_bf16_f32 v12, v36, v37
    v_cvt_pk_bf16_f32 v13, v38, v39
    s_add_u32 m0, s30, 6528
    v_and_or_b32 v26, v26, s40, v1
    buffer_load_dwordx4 v26, s[4:7], 0 offen lds
    s_add_u32 m0, s30, 7616
    v_and_or_b32 v27, v27, s40, v1
    buffer_load_dwordx4 v27, s[4:7], 0 offen lds
    v_mfma_f32_16x16x16_bf16 v[32:35], v[224:225], v[12:13], v[32:35]
    v_mfma_f32_16x16x16_bf16 v[160:163], v[64:65], v[12:13], v[160:163]
    v_mfma_f32_16x16x16_bf16 v[164:167], v[68:69], v[12:13], v[164:167]
    v_mfma_f32_16x16x16_bf16 v[168:171], v[72:73], v[12:13], v[168:171]
    v_mfma_f32_16x16x16_bf16 v[172:175], v[76:77], v[12:13], v[172:175]
    v_mfma_f32_16x16x16_bf16 v[176:179], v[80:81], v[12:13], v[176:179]
    v_mfma_f32_16x16x16_bf16 v[180:183], v[84:85], v[12:13], v[180:183]
    v_mfma_f32_16x16x16_bf16 v[184:187], v[88:89], v[12:13], v[184:187]
    v_mfma_f32_16x16x16_bf16 v[188:191], v[92:93], v[12:13], v[188:191]
    v_add_u32 v2, s31, v2
    s_add_u32 s29, s29, 64
    s_waitcnt vmcnt(8)
    v_add_u32 v0, s29, v5
    v_mfma_f32_16x16x16_bf16 v[192:195], v[96:97], v[12:13], v[192:195]
    ds_read_b128 v[16:19], v0
    v_mfma_f32_16x16x16_bf16 v[196:199], v[100:101], v[12:13], v[196:199]
    ds_read_b128 v[48:51], v2 offset:0
    v_mfma_f32_16x16x16_bf16 v[200:203], v[104:105], v[12:13], v[200:203]
    ds_read_b128 v[52:55], v2 offset:64
    v_mfma_f32_16x16x16_bf16 v[204:207], v[108:109], v[12:13], v[204:207]
    ds_read_b128 v[56:59], v2 offset:128
    v_mfma_f32_16x16x16_bf16 v[208:211], v[112:113], v[12:13], v[208:211]
    ds_read_b128 v[60:63], v2 offset:192
    v_mfma_f32_16x16x16_bf16 v[212:215], v[116:117], v[12:13], v[212:215]
    v_mfma_f32_16x16x16_bf16 v[216:219], v[120:121], v[12:13], v[216:219]
    v_mfma_f32_16x16x16_bf16 v[220:223], v[124:125], v[12:13], v[220:223]
    v_add_u32 v3, s31, v3
    v_add_u32 v4, s31, v4
    s_add_u32 s30, s30, s31
    s_sub_u32 s31, 0, s31
    s_add_u32 s28, s28, 1
    s_mov_b32 s52, 0
    s_branch MAIN_NEXT
TL_0_R2:
    s_cmp_eq_u32 s41, 2
    s_cbranch_scc0 TL_0_R1
    s_waitcnt lgkmcnt(0)
    v_mfma_f32_16x16x32_bf16 v[28:31], v[60:63], v[156:159], v[28:31]
    v_cmp_eq_u32_sdwa s[32:33], v16, v7 src0_sel:BYTE_0 src1_sel:DWORD
    v_cmp_eq_u32_sdwa s[34:35], v17, v7 src0_sel:BYTE_0 src1_sel:DWORD
    v_cmp_eq_u32_sdwa s[36:37], v18, v7 src0_sel:BYTE_0 src1_sel:DWORD
    v_cmp_eq_u32_sdwa s[38:39], v19, v7 src0_sel:BYTE_0 src1_sel:DWORD
    s_nop 3
    v_pk_mul_f32 v[36:37], v[28:29], s[50:51] op_sel_hi:[1,0]
    v_pk_mul_f32 v[38:39], v[30:31], s[50:51] op_sel_hi:[1,0]
    v_max_f32 v36, v36, v28
    v_max_f32 v37, v37, v29
    v_max_f32 v38, v38, v30
    v_max_f32 v39, v39, v31
    v_exp_f32 v36, v36
    v_exp_f32 v37, v37
    v_exp_f32 v38, v38
    v_exp_f32 v39, v39
    v_cndmask_b32 v36, 0, v36, s[32:33]
    v_cndmask_b32 v37, 0, v37, s[34:35]
    v_cndmask_b32 v38, 0, v38, s[36:37]
    v_cndmask_b32 v39, 0, v39, s[38:39]
    v_cvt_pk_bf16_f32 v12, v36, v37
    v_cvt_pk_bf16_f32 v13, v38, v39
    s_nop 1
    v_mfma_f32_16x16x16_bf16 v[32:35], v[224:225], v[12:13], v[32:35]
    v_mfma_f32_16x16x16_bf16 v[160:163], v[64:65], v[12:13], v[160:163]
    v_mfma_f32_16x16x16_bf16 v[164:167], v[68:69], v[12:13], v[164:167]
    v_mfma_f32_16x16x16_bf16 v[168:171], v[72:73], v[12:13], v[168:171]
    v_mfma_f32_16x16x16_bf16 v[172:175], v[76:77], v[12:13], v[172:175]
    v_mfma_f32_16x16x16_bf16 v[176:179], v[80:81], v[12:13], v[176:179]
    v_mfma_f32_16x16x16_bf16 v[180:183], v[84:85], v[12:13], v[180:183]
    v_mfma_f32_16x16x16_bf16 v[184:187], v[88:89], v[12:13], v[184:187]
    v_mfma_f32_16x16x16_bf16 v[188:191], v[92:93], v[12:13], v[188:191]
    v_add_u32 v2, s31, v2
    s_add_u32 s29, s29, 64
    s_waitcnt vmcnt(0)
    v_add_u32 v0, s29, v5
    v_mfma_f32_16x16x16_bf16 v[192:195], v[96:97], v[12:13], v[192:195]
    ds_read_b128 v[16:19], v0
    v_mfma_f32_16x16x16_bf16 v[196:199], v[100:101], v[12:13], v[196:199]
    ds_read_b128 v[48:51], v2 offset:0
    v_mfma_f32_16x16x16_bf16 v[200:203], v[104:105], v[12:13], v[200:203]
    ds_read_b128 v[52:55], v2 offset:64
    v_mfma_f32_16x16x16_bf16 v[204:207], v[108:109], v[12:13], v[204:207]
    ds_read_b128 v[56:59], v2 offset:128
    v_mfma_f32_16x16x16_bf16 v[208:211], v[112:113], v[12:13], v[208:211]
    ds_read_b128 v[60:63], v2 offset:192
    v_mfma_f32_16x16x16_bf16 v[212:215], v[116:117], v[12:13], v[212:215]
    v_mfma_f32_16x16x16_bf16 v[216:219], v[120:121], v[12:13], v[216:219]
    v_mfma_f32_16x16x16_bf16 v[220:223], v[124:125], v[12:13], v[220:223]
    v_add_u32 v3, s31, v3
    v_add_u32 v4, s31, v4
    s_add_u32 s30, s30, s31
    s_sub_u32 s31, 0, s31
    s_add_u32 s28, s28, 1
    s_mov_b32 s52, 0
    s_branch MAIN_NEXT
TL_0_R1:
    s_waitcnt lgkmcnt(0)
    v_mfma_f32_16x16x32_bf16 v[28:31], v[60:63], v[156:159], v[28:31]
    v_cmp_eq_u32_sdwa s[32:33], v16, v7 src0_sel:BYTE_0 src1_sel:DWORD
    v_cmp_eq_u32_sdwa s[34:35], v17, v7 src0_sel:BYTE_0 src1_sel:DWORD
    v_cmp_eq_u32_sdwa s[36:37], v18, v7 src0_sel:BYTE_0 src1_sel:DWORD
    v_cmp_eq_u32_sdwa s[38:39], v19, v7 src0_sel:BYTE_0 src1_sel:DWORD
    s_nop 3
    v_pk_mul_f32 v[36:37], v[28:29], s[50:51] op_sel_hi:[1,0]
    v_pk_mul_f32 v[38:39], v[30:31], s[50:51] op_sel_hi:[1,0]
    v_max_f32 v36, v36, v28
    v_max_f32 v37, v37, v29
    v_max_f32 v38, v38, v30
    v_max_f32 v39, v39, v31
    v_exp_f32 v36, v36
    v_exp_f32 v37, v37
    v_exp_f32 v38, v38
    v_exp_f32 v39, v39
    v_cndmask_b32 v36, 0, v36, s[32:33]
    v_cndmask_b32 v37, 0, v37, s[34:35]
    v_cndmask_b32 v38, 0, v38, s[36:37]
    v_cndmask_b32 v39, 0, v39, s[38:39]
    v_cvt_pk_bf16_f32 v12, v36, v37
    v_cvt_pk_bf16_f32 v13, v38, v39
    s_nop 1
    v_mfma_f32_16x16x16_bf16 v[32:35], v[224:225], v[12:13], v[32:35]
    v_mfma_f32_16x16x16_bf16 v[160:163], v[64:65], v[12:13], v[160:163]
    v_mfma_f32_16x16x16_bf16 v[164:167], v[68:69], v[12:13], v[164:167]
    v_mfma_f32_16x16x16_bf16 v[168:171], v[72:73], v[12:13], v[168:171]
    v_mfma_f32_16x16x16_bf16 v[172:175], v[76:77], v[12:13], v[172:175]
    v_mfma_f32_16x16x16_bf16 v[176:179], v[80:81], v[12:13], v[176:179]
    v_mfma_f32_16x16x16_bf16 v[180:183], v[84:85], v[12:13], v[180:183]
    v_mfma_f32_16x16x16_bf16 v[184:187], v[88:89], v[12:13], v[184:187]
    v_mfma_f32_16x16x16_bf16 v[188:191], v[92:93], v[12:13], v[188:191]
    v_add_u32 v2, s31, v2
    s_add_u32 s29, s29, 64
    v_mfma_f32_16x16x16_bf16 v[192:195], v[96:97], v[12:13], v[192:195]
    v_mfma_f32_16x16x16_bf16 v[196:199], v[100:101], v[12:13], v[196:199]
    v_mfma_f32_16x16x16_bf16 v[200:203], v[104:105], v[12:13], v[200:203]
    v_mfma_f32_16x16x16_bf16 v[204:207], v[108:109], v[12:13], v[204:207]
    v_mfma_f32_16x16x16_bf16 v[208:211], v[112:113], v[12:13], v[208:211]
    v_mfma_f32_16x16x16_bf16 v[212:215], v[116:117], v[12:13], v[212:215]
    v_mfma_f32_16x16x16_bf16 v[216:219], v[120:121], v[12:13], v[216:219]
    v_mfma_f32_16x16x16_bf16 v[220:223], v[124:125], v[12:13], v[220:223]
    v_add_u32 v3, s31, v3
    v_add_u32 v4, s31, v4
    s_add_u32 s30, s30, s31
    s_sub_u32 s31, 0, s31
    s_add_u32 s28, s28, 1
    s_mov_b32 s52, 0
    s_branch MAIN_NEXT
TL_F1:
    s_cmp_ge_u32 s41, 3
    s_cbranch_scc0 TL_1_R2
    s_waitcnt lgkmcnt(0)
    v_mfma_f32_16x16x32_bf16 v[28:31], v[60:63], v[156:159], v[28:31]
    s_mov_b32 m0, s30
    v_and_or_b32 v20, v20, s40, v1
    buffer_load_dwordx4 v20, s[4:7], 0 offen lds
    s_add_u32 m0, s30, 1088
    v_and_or_b32 v21, v21, s40, v1
    buffer_load_dwordx4 v21, s[4:7], 0 offen lds
    v_cmp_eq_u32_sdwa s[32:33], v16, v7 src0_sel:BYTE_0 src1_sel:DWORD
    v_cmp_eq_u32_sdwa s[34:35], v17, v7 src0_sel:BYTE_0 src1_sel:DWORD
    v_cmp_eq_u32_sdwa s[36:37], v18, v7 src0_sel:BYTE_0 src1_sel:DWORD
    v_cmp_eq_u32_sdwa s[38:39], v19, v7 src0_sel:BYTE_0 src1_sel:DWORD
    v_pk_mul_f32 v[36:37], v[28:29], s[50:51] op_sel_hi:[1,0]
    v_pk_mul_f32 v[38:39], v[30:31], s[50:51] op_sel_hi:[1,0]
    s_add_u32 m0, s30, 2176
    v_and_or_b32 v22, v22, s40, v1
    buffer_load_dwordx4 v22, s[4:7], 0 offen lds
    v_max_f32 v36, v36, v28
    v_max_f32 v37, v37, v29
    v_max_f32 v38, v38, v30
    v_max_f32 v39, v39, v31
    s_add_u32 m0, s30, 3264
    v_and_or_b32 v23, v23, s40, v1
    buffer_load_dwordx4 v23, s[4:7], 0 offen lds
    v_exp_f32 v36, v36
    v_exp_f32 v37, v37
    v_exp_f32 v38, v38
    v_exp_f32 v39, v39
    s_add_u32 m0, s30, 4352
    v_and_or_b32 v24, v24, s40, v1
    buffer_load_dwordx4 v24, s[4:7], 0 offen lds
    v_cndmask_b32 v36, 0, v36, s[32:33]
    v_cndmask_b32 v37, 0, v37, s[34:35]
    v_cndmask_b32 v38, 0, v38, s[36:37]
    v_cndmask_b32 v39, 0, v39, s[38:39]
    s_add_u32 m0, s30, 5440
    v_and_or_b32 v25, v25, s40, v1
    buffer_load_dwordx4 v25, s[4:7], 0 offen lds
    v_cvt_pk_bf16_f32 v12, v36, v37
    v_cvt_pk_bf16_f32 v13, v38, v39
    s_add_u32 m0, s30, 6528
    v_and_or_b32 v26, v26, s40, v1
    buffer_load_dwordx4 v26, s[4:7], 0 offen lds
    s_add_u32 m0, s30, 7616
    v_and_or_b32 v27, v27, s40, v1
    buffer_load_dwordx4 v27, s[4:7], 0 offen lds
    v_mfma_f32_16x16x16_bf16 v[32:35], v[224:225], v[12:13], 0
    v_mfma_f32_16x16x16_bf16 v[160:163], v[64:65], v[12:13], 0
    v_mfma_f32_16x16x16_bf16 v[164:167], v[68:69], v[12:13], 0
    v_mfma_f32_16x16x16_bf16 v[168:171], v[72:73], v[12:13], 0
    v_mfma_f32_16x16x16_bf16 v[172:175], v[76:77], v[12:13], 0
    v_mfma_f32_16x16x16_bf16 v[176:179], v[80:81], v[12:13], 0
    v_mfma_f32_16x16x16_bf16 v[180:183], v[84:85], v[12:13], 0
    v_mfma_f32_16x16x16_bf16 v[184:187], v[88:89], v[12:13], 0
    v_mfma_f32_16x16x16_bf16 v[188:191], v[92:93], v[12:13], 0
    v_add_u32 v2, s31, v2
    s_add_u32 s29, s29, 64
    s_waitcnt vmcnt(8)
    v_add_u32 v0, s29, v5
    v_mfma_f32_16x16x16_bf16 v[192:195], v[96:97], v[12:13], 0
    ds_read_b128 v[16:19], v0
    v_mfma_f32_16x16x16_bf16 v[196:199], v[100:101], v[12:13], 0
    ds_read_b128 v[48:51], v2 offset:0
    v_mfma_f32_16x16x16_bf16 v[200:203], v[104:105], v[12:13], 0
    ds_read_b128 v[52:55], v2 offset:64
    v_mfma_f32_16x16x16_bf16 v[204:207], v[108:109], v[12:13], 0
    ds_read_b128 v[56:59], v2 offset:128
    v_mfma_f32_16x16x16_bf16 v[208:211], v[112:113], v[12:13], 0
    ds_read_b128 v[60:63], v2 offset:192
    v_mfma_f32_16x16x16_bf16 v[212:215], v[116:117], v[12:13], 0
    v_mfma_f32_16x16x16_bf16 v[216:219], v[120:121], v[12:13], 0
    v_mfma_f32_16x16x16_bf16 v[220:223], v[124:125], v[12:13], 0
    v_add_u32 v3, s31, v3
    v_add_u32 v4, s31, v4
    s_add_u32 s30, s30, s31
    s_sub_u32 s31, 0, s31
    s_add_u32 s28, s28, 1
    s_mov_b32 s52, 0
    s_branch MAIN_NEXT
TL_1_R2:
    s_cmp_eq_u32 s41, 2
    s_cbranch_scc0 TL_1_R1
    s_waitcnt lgkmcnt(0)
    v_mfma_f32_16x16x32_bf16 v[28:31], v[60:63], v[156:159], v[28:31]
    v_cmp_eq_u32_sdwa s[32:33], v16, v7 src0_sel:BYTE_0 src1_sel:DWORD
    v_cmp_eq_u32_sdwa s[34:35], v17, v7 src0_sel:BYTE_0 src1_sel:DWORD
    v_cmp_eq_u32_sdwa s[36:37], v18, v7 src0_sel:BYTE_0 src1_sel:DWORD
    v_cmp_eq_u32_sdwa s[38:39], v19, v7 src0_sel:BYTE_0 src1_sel:DWORD
    s_nop 3
    v_pk_mul_f32 v[36:37], v[28:29], s[50:51] op_sel_hi:[1,0]
    v_pk_mul_f32 v[38:39], v[30:31], s[50:51] op_sel_hi:[1,0]
    v_max_f32 v36, v36, v28
    v_max_f32 v37, v37, v29
    v_max_f32 v38, v38, v30
    v_max_f32 v39, v39, v31
    v_exp_f32 v36, v36
    v_exp_f32 v37, v37
    v_exp_f32 v38, v38
    v_exp_f32 v39, v39
    v_cndmask_b32 v36, 0, v36, s[32:33]
    v_cndmask_b32 v37, 0, v37, s[34:35]
    v_cndmask_b32 v38, 0, v38, s[36:37]
    v_cndmask_b32 v39, 0, v39, s[38:39]
    v_cvt_pk_bf16_f32 v12, v36, v37
    v_cvt_pk_bf16_f32 v13, v38, v39
    s_nop 1
    v_mfma_f32_16x16x16_bf16 v[32:35], v[224:225], v[12:13], 0
    v_mfma_f32_16x16x16_bf16 v[160:163], v[64:65], v[12:13], 0
    v_mfma_f32_16x16x16_bf16 v[164:167], v[68:69], v[12:13], 0
    v_mfma_f32_16x16x16_bf16 v[168:171], v[72:73], v[12:13], 0
    v_mfma_f32_16x16x16_bf16 v[172:175], v[76:77], v[12:13], 0
    v_mfma_f32_16x16x16_bf16 v[176:179], v[80:81], v[12:13], 0
    v_mfma_f32_16x16x16_bf16 v[180:183], v[84:85], v[12:13], 0
    v_mfma_f32_16x16x16_bf16 v[184:187], v[88:89], v[12:13], 0
    v_mfma_f32_16x16x16_bf16 v[188:191], v[92:93], v[12:13], 0
    v_add_u32 v2, s31, v2
    s_add_u32 s29, s29, 64
    s_waitcnt vmcnt(0)
    v_add_u32 v0, s29, v5
    v_mfma_f32_16x16x16_bf16 v[192:195], v[96:97], v[12:13], 0
    ds_read_b128 v[16:19], v0
    v_mfma_f32_16x16x16_bf16 v[196:199], v[100:101], v[12:13], 0
    ds_read_b128 v[48:51], v2 offset:0
    v_mfma_f32_16x16x16_bf16 v[200:203], v[104:105], v[12:13], 0
    ds_read_b128 v[52:55], v2 offset:64
    v_mfma_f32_16x16x16_bf16 v[204:207], v[108:109], v[12:13], 0
    ds_read_b128 v[56:59], v2 offset:128
    v_mfma_f32_16x16x16_bf16 v[208:211], v[112:113], v[12:13], 0
    ds_read_b128 v[60:63], v2 offset:192
    v_mfma_f32_16x16x16_bf16 v[212:215], v[116:117], v[12:13], 0
    v_mfma_f32_16x16x16_bf16 v[216:219], v[120:121], v[12:13], 0
    v_mfma_f32_16x16x16_bf16 v[220:223], v[124:125], v[12:13], 0
    v_add_u32 v3, s31, v3
    v_add_u32 v4, s31, v4
    s_add_u32 s30, s30, s31
    s_sub_u32 s31, 0, s31
    s_add_u32 s28, s28, 1
    s_mov_b32 s52, 0
    s_branch MAIN_NEXT
TL_1_R1:
    s_waitcnt lgkmcnt(0)
    v_mfma_f32_16x16x32_bf16 v[28:31], v[60:63], v[156:159], v[28:31]
    v_cmp_eq_u32_sdwa s[32:33], v16, v7 src0_sel:BYTE_0 src1_sel:DWORD
    v_cmp_eq_u32_sdwa s[34:35], v17, v7 src0_sel:BYTE_0 src1_sel:DWORD
    v_cmp_eq_u32_sdwa s[36:37], v18, v7 src0_sel:BYTE_0 src1_sel:DWORD
    v_cmp_eq_u32_sdwa s[38:39], v19, v7 src0_sel:BYTE_0 src1_sel:DWORD
    s_nop 3
    v_pk_mul_f32 v[36:37], v[28:29], s[50:51] op_sel_hi:[1,0]
    v_pk_mul_f32 v[38:39], v[30:31], s[50:51] op_sel_hi:[1,0]
    v_max_f32 v36, v36, v28
    v_max_f32 v37, v37, v29
    v_max_f32 v38, v38, v30
    v_max_f32 v39, v39, v31
    v_exp_f32 v36, v36
    v_exp_f32 v37, v37
    v_exp_f32 v38, v38
    v_exp_f32 v39, v39
    v_cndmask_b32 v36, 0, v36, s[32:33]
    v_cndmask_b32 v37, 0, v37, s[34:35]
    v_cndmask_b32 v38, 0, v38, s[36:37]
    v_cndmask_b32 v39, 0, v39, s[38:39]
    v_cvt_pk_bf16_f32 v12, v36, v37
    v_cvt_pk_bf16_f32 v13, v38, v39
    s_nop 1
    v_mfma_f32_16x16x16_bf16 v[32:35], v[224:225], v[12:13], 0
    v_mfma_f32_16x16x16_bf16 v[160:163], v[64:65], v[12:13], 0
    v_mfma_f32_16x16x16_bf16 v[164:167], v[68:69], v[12:13], 0
    v_mfma_f32_16x16x16_bf16 v[168:171], v[72:73], v[12:13], 0
    v_mfma_f32_16x16x16_bf16 v[172:175], v[76:77], v[12:13], 0
    v_mfma_f32_16x16x16_bf16 v[176:179], v[80:81], v[12:13], 0
    v_mfma_f32_16x16x16_bf16 v[180:183], v[84:85], v[12:13], 0
    v_mfma_f32_16x16x16_bf16 v[184:187], v[88:89], v[12:13], 0
    v_mfma_f32_16x16x16_bf16 v[188:191], v[92:93], v[12:13], 0
    v_add_u32 v2, s31, v2
    s_add_u32 s29, s29, 64
    v_mfma_f32_16x16x16_bf16 v[192:195], v[96:97], v[12:13], 0
    v_mfma_f32_16x16x16_bf16 v[196:199], v[100:101], v[12:13], 0
    v_mfma_f32_16x16x16_bf16 v[200:203], v[104:105], v[12:13], 0
    v_mfma_f32_16x16x16_bf16 v[204:207], v[108:109], v[12:13], 0
    v_mfma_f32_16x16x16_bf16 v[208:211], v[112:113], v[12:13], 0
    v_mfma_f32_16x16x16_bf16 v[212:215], v[116:117], v[12:13], 0
    v_mfma_f32_16x16x16_bf16 v[216:219], v[120:121], v[12:13], 0
    v_mfma_f32_16x16x16_bf16 v[220:223], v[124:125], v[12:13], 0
    v_add_u32 v3, s31, v3
    v_add_u32 v4, s31, v4
    s_add_u32 s30, s30, s31
    s_sub_u32 s31, 0, s31
    s_add_u32 s28, s28, 1
    s_mov_b32 s52, 0
    s_branch MAIN_NEXT
MAIN_ODD:
    s_add_u32 s46, s29, 128
    s_cmp_ge_u32 s28, 2
    s_cbranch_scc1 PR_22
    s_setprio 3
    s_branch PR_24
PR_22:
    s_cmp_ge_u32 s28, 4
    s_cbranch_scc1 PR_23
    s_setprio 2
    s_branch PR_24
PR_23:
    s_setprio 1
PR_24:
    v_add_u32 v42, s46, v6
    s_waitcnt lgkmcnt(3)
    v_mfma_f32_16x16x32_bf16 v[28:31], v[48:51], v[128:131], v[8:11]
    ds_read_b128 v[48:51], v2 offset:256
    ds_read_b64_tr_b16 v[66:67], v3 offset:0
    ds_read_b64_tr_b16 v[70:71], v4 offset:32
    ds_read_b64_tr_b16 v[74:75], v3 offset:64
    ds_read_b64_tr_b16 v[78:79], v4 offset:96
    s_waitcnt lgkmcnt(7)
    v_mfma_f32_16x16x32_bf16 v[28:31], v[52:55], v[132:135], v[28:31]
    ds_read_b128 v[52:55], v2 offset:320
    ds_read_b64_tr_b16 v[82:83], v3 offset:128
    ds_read_b64_tr_b16 v[86:87], v4 offset:160
    ds_read_b64_tr_b16 v[90:91], v3 offset:192
    ds_read_b64_tr_b16 v[94:95], v4 offset:224
    s_waitcnt lgkmcnt(11)
    v_mfma_f32_16x16x32_bf16 v[28:31], v[56:59], v[136:139], v[28:31]
    ds_read_b128 v[56:59], v2 offset:384
    ds_read_b64_tr_b16 v[98:99], v3 offset:256
    ds_read_b64_tr_b16 v[102:103], v4 offset:288
    ds_read_b64_tr_b16 v[106:107], v3 offset:320
    ds_read_b64_tr_b16 v[110:111], v4 offset:352
    s_waitcnt lgkmcnt(14)
    v_mfma_f32_16x16x32_bf16 v[28:31], v[60:63], v[140:143], v[28:31]
    ds_read_b128 v[60:63], v2 offset:448
    ds_read_b64_tr_b16 v[114:115], v3 offset:384
    ds_read_b64_tr_b16 v[118:119], v4 offset:416
    ds_read_b64_tr_b16 v[122:123], v3 offset:448
    ds_read_b64_tr_b16 v[126:127], v4 offset:480
    ds_read2_b32 v[20:21], v42 offset0:0 offset1:2
    ds_read2_b32 v[22:23], v42 offset0:4 offset1:6
    ds_read2_b32 v[24:25], v42 offset0:8 offset1:10
    ds_read2_b32 v[26:27], v42 offset0:12 offset1:14
    s_waitcnt lgkmcnt(14)
    v_mfma_f32_16x16x32_bf16 v[28:31], v[48:51], v[144:147], v[28:31]
    s_waitcnt lgkmcnt(14)
    v_mfma_f32_16x16x32_bf16 v[28:31], v[52:55], v[148:151], v[28:31]
    s_waitcnt lgkmcnt(13)
    v_mfma_f32_16x16x32_bf16 v[28:31], v[56:59], v[152:155], v[28:31]
    s_sub_u32 s41, s27, s28
    s_cmp_eq_u32 s52, 0
    s_cbranch_scc0 TO_F1
    s_cmp_ge_u32 s41, 3
    s_cbranch_scc0 TO_0_R2
    s_waitcnt lgkmcnt(0)
    v_mfma_f32_16x16x32_bf16 v[28:31], v[60:63], v[156:159], v[28:31]
    s_mov_b32 m0, s30
    v_and_or_b32 v20, v20, s40, v1
    buffer_load_dwordx4 v20, s[4:7], 0 offen lds
    s_add_u32 m0, s30, 1088
    v_and_or_b32 v21, v21, s40, v1
    buffer_load_dwordx4 v21, s[4:7], 0 offen lds
    v_cmp_eq_u32_sdwa s[32:33], v16, v7 src0_sel:BYTE_0 src1_sel:DWORD
    v_cmp_eq_u32_sdwa s[34:35], v17, v7 src0_sel:BYTE_0 src1_sel:DWORD
    v_cmp_eq_u32_sdwa s[36:37], v18, v7 src0_sel:BYTE_0 src1_sel:DWORD
    v_cmp_eq_u32_sdwa s[38:39], v19, v7 src0_sel:BYTE_0 src1_sel:DWORD
    v_pk_mul_f32 v[36:37], v[28:29], s[50:51] op_sel_hi:[1,0]
    v_pk_mul_f32 v[38:39], v[30:31], s[50:51] op_sel_hi:[1,0]
    s_add_u32 m0, s30, 2176
    v_and_or_b32 v22, v22, s40, v1
    buffer_load_dwordx4 v22, s[4:7], 0 offen lds
    v_max_f32 v36, v36, v28
    v_max_f32 v37, v37, v29
    v_max_f32 v38, v38, v30
    v_max_f32 v39, v39, v31
    s_add_u32 m0, s30, 3264
    v_and_or_b32 v23, v23, s40, v1
    buffer_load_dwordx4 v23, s[4:7], 0 offen lds
    v_exp_f32 v36, v36
    v_exp_f32 v37, v37
    v_exp_f32 v38, v38
    v_exp_f32 v39, v39
    s_add_u32 m0, s30, 4352
    v_and_or_b32 v24, v24, s40, v1
    buffer_load_dwordx4 v24, s[4:7], 0 offen lds
    v_cndmask_b32 v36, 0, v36, s[32:33]
    v_cndmask_b32 v37, 0, v37, s[34:35]
    v_cndmask_b32 v38, 0, v38, s[36:37]
    v_cndmask_b32 v39, 0, v39, s[38:39]
    s_add_u32 m0, s30, 5440
    v_and_or_b32 v25, v25, s40, v1
    buffer_load_dwordx4 v25, s[4:7], 0 offen lds
    v_cvt_pk_bf16_f32 v14, v36, v37
    v_cvt_pk_bf16_f32 v15, v38, v39
    s_add_u32 m0, s30, 6528
    v_and_or_b32 v26, v26, s40, v1
    buffer_load_dwordx4 v26, s[4:7], 0 offen lds
    s_add_u32 m0, s30, 7616
    v_and_or_b32 v27, v27, s40, v1
    buffer_load_dwordx4 v27, s[4:7], 0 offen lds
    v_mfma_f32_16x16x32_bf16 v[32:35], v[224:227], v[12:15], v[32:35]
    v_mfma_f32_16x16x32_bf16 v[160:163], v[64:67], v[12:15], v[160:163]
    v_mfma_f32_16x16x32_bf16 v[164:167], v[68:71], v[12:15], v[164:167]
    v_mfma_f32_16x16x32_bf16 v[168:171], v[72:75], v[12:15], v[168:171]
    v_mfma_f32_16x16x32_bf16 v[172:175], v[76:79], v[12:15], v[172:175]
    v_mfma_f32_16x16x32_bf16 v[176:179], v[80:83], v[12:15], v[176:179]
    v_mfma_f32_16x16x32_bf16 v[180:183], v[84:87], v[12:15], v[180:183]
    v_mfma_f32_16x16x32_bf16 v[184:187], v[88:91], v[12:15], v[184:187]
    v_mfma_f32_16x16x32_bf16 v[188:191], v[92:95], v[12:15], v[188:191]
    v_add_u32 v2, s31, v2
    s_add_u32 s29, s29, 64
    s_waitcnt vmcnt(8)
    v_add_u32 v0, s29, v5
    v_mfma_f32_16x16x32_bf16 v[192:195], v[96:99], v[12:15], v[192:195]
    ds_read_b128 v[16:19], v0
    v_mfma_f32_16x16x32_bf16 v[196:199], v[100:103], v[12:15], v[196:199]
    ds_read_b128 v[48:51], v2 offset:0
    v_mfma_f32_16x16x32_bf16 v[200:203], v[104:107], v[12:15], v[200:203]
    ds_read_b128 v[52:55], v2 offset:64
    v_mfma_f32_16x16x32_bf16 v[204:207], v[108:111], v[12:15], v[204:207]
    ds_read_b128 v[56:59], v2 offset:128
    v_mfma_f32_16x16x32_bf16 v[208:211], v[112:115], v[12:15], v[208:211]
    ds_read_b128 v[60:63], v2 offset:192
    v_mfma_f32_16x16x32_bf16 v[212:215], v[116:119], v[12:15], v[212:215]
    v_mfma_f32_16x16x32_bf16 v[216:219], v[120:123], v[12:15], v[216:219]
    v_mfma_f32_16x16x32_bf16 v[220:223], v[124:127], v[12:15], v[220:223]
    v_add_u32 v3, s31, v3
    v_add_u32 v4, s31, v4
    s_add_u32 s30, s30, s31
    s_sub_u32 s31, 0, s31
    s_add_u32 s28, s28, 1
    s_mov_b32 s52, 0
    s_branch MAIN_NEXT
TO_0_R2:
    s_cmp_eq_u32 s41, 2
    s_cbranch_scc0 TO_0_R1
    s_waitcnt lgkmcnt(0)
    v_mfma_f32_16x16x32_bf16 v[28:31], v[60:63], v[156:159], v[28:31]
    v_cmp_eq_u32_sdwa s[32:33], v16, v7 src0_sel:BYTE_0 src1_sel:DWORD
    v_cmp_eq_u32_sdwa s[34:35], v17, v7 src0_sel:BYTE_0 src1_sel:DWORD
    v_cmp_eq_u32_sdwa s[36:37], v18, v7 src0_sel:BYTE_0 src1_sel:DWORD
    v_cmp_eq_u32_sdwa s[38:39], v19, v7 src0_sel:BYTE_0 src1_sel:DWORD
    s_nop 3
    v_pk_mul_f32 v[36:37], v[28:29], s[50:51] op_sel_hi:[1,0]
    v_pk_mul_f32 v[38:39], v[30:31], s[50:51] op_sel_hi:[1,0]
    v_max_f32 v36, v36, v28
    v_max_f32 v37, v37, v29
    v_max_f32 v38, v38, v30
    v_max_f32 v39, v39, v31
    v_exp_f32 v36, v36
    v_exp_f32 v37, v37
    v_exp_f32 v38, v38
    v_exp_f32 v39, v39
    v_cndmask_b32 v36, 0, v36, s[32:33]
    v_cndmask_b32 v37, 0, v37, s[34:35]
    v_cndmask_b32 v38, 0, v38, s[36:37]
    v_cndmask_b32 v39, 0, v39, s[38:39]
    v_cvt_pk_bf16_f32 v14, v36, v37
    v_cvt_pk_bf16_f32 v15, v38, v39
    s_nop 1
    v_mfma_f32_16x16x32_bf16 v[32:35], v[224:227], v[12:15], v[32:35]
    v_mfma_f32_16x16x32_bf16 v[160:163], v[64:67], v[12:15], v[160:163]
    v_mfma_f32_16x16x32_bf16 v[164:167], v[68:71], v[12:15], v[164:167]
    v_mfma_f32_16x16x32_bf16 v[168:171], v[72:75], v[12:15], v[168:171]
    v_mfma_f32_16x16x32_bf16 v[172:175], v[76:79], v[12:15], v[172:175]
    v_mfma_f32_16x16x32_bf16 v[176:179], v[80:83], v[12:15], v[176:179]
    v_mfma_f32_16x16x32_bf16 v[180:183], v[84:87], v[12:15], v[180:183]
    v_mfma_f32_16x16x32_bf16 v[184:187], v[88:91], v[12:15], v[184:187]
    v_mfma_f32_16x16x32_bf16 v[188:191], v[92:95], v[12:15], v[188:191]
    v_add_u32 v2, s31, v2
    s_add_u32 s29, s29, 64
    s_waitcnt vmcnt(0)
    v_add_u32 v0, s29, v5
    v_mfma_f32_16x16x32_bf16 v[192:195], v[96:99], v[12:15], v[192:195]
    ds_read_b128 v[16:19], v0
    v_mfma_f32_16x16x32_bf16 v[196:199], v[100:103], v[12:15], v[196:199]
    ds_read_b128 v[48:51], v2 offset:0
    v_mfma_f32_16x16x32_bf16 v[200:203], v[104:107], v[12:15], v[200:203]
    ds_read_b128 v[52:55], v2 offset:64
    v_mfma_f32_16x16x32_bf16 v[204:207], v[108:111], v[12:15], v[204:207]
    ds_read_b128 v[56:59], v2 offset:128
    v_mfma_f32_16x16x32_bf16 v[208:211], v[112:115], v[12:15], v[208:211]
    ds_read_b128 v[60:63], v2 offset:192
    v_mfma_f32_16x16x32_bf16 v[212:215], v[116:119], v[12:15], v[212:215]
    v_mfma_f32_16x16x32_bf16 v[216:219], v[120:123], v[12:15], v[216:219]
    v_mfma_f32_16x16x32_bf16 v[220:223], v[124:127], v[12:15], v[220:223]
    v_add_u32 v3, s31, v3
    v_add_u32 v4, s31, v4
    s_add_u32 s30, s30, s31
    s_sub_u32 s31, 0, s31
    s_add_u32 s28, s28, 1
    s_mov_b32 s52, 0
    s_branch MAIN_NEXT
TO_0_R1:
    s_waitcnt lgkmcnt(0)
    v_mfma_f32_16x16x32_bf16 v[28:31], v[60:63], v[156:159], v[28:31]
    v_cmp_eq_u32_sdwa s[32:33], v16, v7 src0_sel:BYTE_0 src1_sel:DWORD
    v_cmp_eq_u32_sdwa s[34:35], v17, v7 src0_sel:BYTE_0 src1_sel:DWORD
    v_cmp_eq_u32_sdwa s[36:37], v18, v7 src0_sel:BYTE_0 src1_sel:DWORD
    v_cmp_eq_u32_sdwa s[38:39], v19, v7 src0_sel:BYTE_0 src1_sel:DWORD
    s_nop 3
    v_pk_mul_f32 v[36:37], v[28:29], s[50:51] op_sel_hi:[1,0]
    v_pk_mul_f32 v[38:39], v[30:31], s[50:51] op_sel_hi:[1,0]
    v_max_f32 v36, v36, v28
    v_max_f32 v37, v37, v29
    v_max_f32 v38, v38, v30
    v_max_f32 v39, v39, v31
    v_exp_f32 v36, v36
    v_exp_f32 v37, v37
    v_exp_f32 v38, v38
    v_exp_f32 v39, v39
    v_cndmask_b32 v36, 0, v36, s[32:33]
    v_cndmask_b32 v37, 0, v37, s[34:35]
    v_cndmask_b32 v38, 0, v38, s[36:37]
    v_cndmask_b32 v39, 0, v39, s[38:39]
    v_cvt_pk_bf16_f32 v14, v36, v37
    v_cvt_pk_bf16_f32 v15, v38, v39
    s_nop 1
    v_mfma_f32_16x16x32_bf16 v[32:35], v[224:227], v[12:15], v[32:35]
    v_mfma_f32_16x16x32_bf16 v[160:163], v[64:67], v[12:15], v[160:163]
    v_mfma_f32_16x16x32_bf16 v[164:167], v[68:71], v[12:15], v[164:167]
    v_mfma_f32_16x16x32_bf16 v[168:171], v[72:75], v[12:15], v[168:171]
    v_mfma_f32_16x16x32_bf16 v[172:175], v[76:79], v[12:15], v[172:175]
    v_mfma_f32_16x16x32_bf16 v[176:179], v[80:83], v[12:15], v[176:179]
    v_mfma_f32_16x16x32_bf16 v[180:183], v[84:87], v[12:15], v[180:183]
    v_mfma_f32_16x16x32_bf16 v[184:187], v[88:91], v[12:15], v[184:187]
    v_mfma_f32_16x16x32_bf16 v[188:191], v[92:95], v[12:15], v[188:191]
    v_add_u32 v2, s31, v2
    s_add_u32 s29, s29, 64
    v_mfma_f32_16x16x32_bf16 v[192:195], v[96:99], v[12:15], v[192:195]
    v_mfma_f32_16x16x32_bf16 v[196:199], v[100:103], v[12:15], v[196:199]
    v_mfma_f32_16x16x32_bf16 v[200:203], v[104:107], v[12:15], v[200:203]
    v_mfma_f32_16x16x32_bf16 v[204:207], v[108:111], v[12:15], v[204:207]
    v_mfma_f32_16x16x32_bf16 v[208:211], v[112:115], v[12:15], v[208:211]
    v_mfma_f32_16x16x32_bf16 v[212:215], v[116:119], v[12:15], v[212:215]
    v_mfma_f32_16x16x32_bf16 v[216:219], v[120:123], v[12:15], v[216:219]
    v_mfma_f32_16x16x32_bf16 v[220:223], v[124:127], v[12:15], v[220:223]
    v_add_u32 v3, s31, v3
    v_add_u32 v4, s31, v4
    s_add_u32 s30, s30, s31
    s_sub_u32 s31, 0, s31
    s_add_u32 s28, s28, 1
    s_mov_b32 s52, 0
    s_branch MAIN_NEXT
TO_F1:
    s_cmp_ge_u32 s41, 3
    s_cbranch_scc0 TO_1_R2
    s_waitcnt lgkmcnt(0)
    v_mfma_f32_16x16x32_bf16 v[28:31], v[60:63], v[156:159], v[28:31]
    s_mov_b32 m0, s30
    v_and_or_b32 v20, v20, s40, v1
    buffer_load_dwordx4 v20, s[4:7], 0 offen lds
    s_add_u32 m0, s30, 1088
    v_and_or_b32 v21, v21, s40, v1
    buffer_load_dwordx4 v21, s[4:7], 0 offen lds
    v_cmp_eq_u32_sdwa s[32:33], v16, v7 src0_sel:BYTE_0 src1_sel:DWORD
    v_cmp_eq_u32_sdwa s[34:35], v17, v7 src0_sel:BYTE_0 src1_sel:DWORD
    v_cmp_eq_u32_sdwa s[36:37], v18, v7 src0_sel:BYTE_0 src1_sel:DWORD
    v_cmp_eq_u32_sdwa s[38:39], v19, v7 src0_sel:BYTE_0 src1_sel:DWORD
    v_pk_mul_f32 v[36:37], v[28:29], s[50:51] op_sel_hi:[1,0]
    v_pk_mul_f32 v[38:39], v[30:31], s[50:51] op_sel_hi:[1,0]
    s_add_u32 m0, s30, 2176
    v_and_or_b32 v22, v22, s40, v1
    buffer_load_dwordx4 v22, s[4:7], 0 offen lds
    v_max_f32 v36, v36, v28
    v_max_f32 v37, v37, v29
    v_max_f32 v38, v38, v30
    v_max_f32 v39, v39, v31
    s_add_u32 m0, s30, 3264
    v_and_or_b32 v23, v23, s40, v1
    buffer_load_dwordx4 v23, s[4:7], 0 offen lds
    v_exp_f32 v36, v36
    v_exp_f32 v37, v37
    v_exp_f32 v38, v38
    v_exp_f32 v39, v39
    s_add_u32 m0, s30, 4352
    v_and_or_b32 v24, v24, s40, v1
    buffer_load_dwordx4 v24, s[4:7], 0 offen lds
    v_cndmask_b32 v36, 0, v36, s[32:33]
    v_cndmask_b32 v37, 0, v37, s[34:35]
    v_cndmask_b32 v38, 0, v38, s[36:37]
    v_cndmask_b32 v39, 0, v39, s[38:39]
    s_add_u32 m0, s30, 5440
    v_and_or_b32 v25, v25, s40, v1
    buffer_load_dwordx4 v25, s[4:7], 0 offen lds
    v_cvt_pk_bf16_f32 v14, v36, v37
    v_cvt_pk_bf16_f32 v15, v38, v39
    s_add_u32 m0, s30, 6528
    v_and_or_b32 v26, v26, s40, v1
    buffer_load_dwordx4 v26, s[4:7], 0 offen lds
    s_add_u32 m0, s30, 7616
    v_and_or_b32 v27, v27, s40, v1
    buffer_load_dwordx4 v27, s[4:7], 0 offen lds
    v_mfma_f32_16x16x32_bf16 v[32:35], v[224:227], v[12:15], 0
    v_mfma_f32_16x16x32_bf16 v[160:163], v[64:67], v[12:15], 0
    v_mfma_f32_16x16x32_bf16 v[164:167], v[68:71], v[12:15], 0
    v_mfma_f32_16x16x32_bf16 v[168:171], v[72:75], v[12:15], 0
    v_mfma_f32_16x16x32_bf16 v[172:175], v[76:79], v[12:15], 0
    v_mfma_f32_16x16x32_bf16 v[176:179], v[80:83], v[12:15], 0
    v_mfma_f32_16x16x32_bf16 v[180:183], v[84:87], v[12:15], 0
    v_mfma_f32_16x16x32_bf16 v[184:187], v[88:91], v[12:15], 0
    v_mfma_f32_16x16x32_bf16 v[188:191], v[92:95], v[12:15], 0
    v_add_u32 v2, s31, v2
    s_add_u32 s29, s29, 64
    s_waitcnt vmcnt(8)
    v_add_u32 v0, s29, v5
    v_mfma_f32_16x16x32_bf16 v[192:195], v[96:99], v[12:15], 0
    ds_read_b128 v[16:19], v0
    v_mfma_f32_16x16x32_bf16 v[196:199], v[100:103], v[12:15], 0
    ds_read_b128 v[48:51], v2 offset:0
    v_mfma_f32_16x16x32_bf16 v[200:203], v[104:107], v[12:15], 0
    ds_read_b128 v[52:55], v2 offset:64
    v_mfma_f32_16x16x32_bf16 v[204:207], v[108:111], v[12:15], 0
    ds_read_b128 v[56:59], v2 offset:128
    v_mfma_f32_16x16x32_bf16 v[208:211], v[112:115], v[12:15], 0
    ds_read_b128 v[60:63], v2 offset:192
    v_mfma_f32_16x16x32_bf16 v[212:215], v[116:119], v[12:15], 0
    v_mfma_f32_16x16x32_bf16 v[216:219], v[120:123], v[12:15], 0
    v_mfma_f32_16x16x32_bf16 v[220:223], v[124:127], v[12:15], 0
    v_add_u32 v3, s31, v3
    v_add_u32 v4, s31, v4
    s_add_u32 s30, s30, s31
    s_sub_u32 s31, 0, s31
    s_add_u32 s28, s28, 1
    s_mov_b32 s52, 0
    s_branch MAIN_NEXT
TO_1_R2:
    s_cmp_eq_u32 s41, 2
    s_cbranch_scc0 TO_1_R1
    s_waitcnt lgkmcnt(0)
    v_mfma_f32_16x16x32_bf16 v[28:31], v[60:63], v[156:159], v[28:31]
    v_cmp_eq_u32_sdwa s[32:33], v16, v7 src0_sel:BYTE_0 src1_sel:DWORD
    v_cmp_eq_u32_sdwa s[34:35], v17, v7 src0_sel:BYTE_0 src1_sel:DWORD
    v_cmp_eq_u32_sdwa s[36:37], v18, v7 src0_sel:BYTE_0 src1_sel:DWORD
    v_cmp_eq_u32_sdwa s[38:39], v19, v7 src0_sel:BYTE_0 src1_sel:DWORD
    s_nop 3
    v_pk_mul_f32 v[36:37], v[28:29], s[50:51] op_sel_hi:[1,0]
    v_pk_mul_f32 v[38:39], v[30:31], s[50:51] op_sel_hi:[1,0]
    v_max_f32 v36, v36, v28
    v_max_f32 v37, v37, v29
    v_max_f32 v38, v38, v30
    v_max_f32 v39, v39, v31
    v_exp_f32 v36, v36
    v_exp_f32 v37, v37
    v_exp_f32 v38, v38
    v_exp_f32 v39, v39
    v_cndmask_b32 v36, 0, v36, s[32:33]
    v_cndmask_b32 v37, 0, v37, s[34:35]
    v_cndmask_b32 v38, 0, v38, s[36:37]
    v_cndmask_b32 v39, 0, v39, s[38:39]
    v_cvt_pk_bf16_f32 v14, v36, v37
    v_cvt_pk_bf16_f32 v15, v38, v39
    s_nop 1
    v_mfma_f32_16x16x32_bf16 v[32:35], v[224:227], v[12:15], 0
    v_mfma_f32_16x16x32_bf16 v[160:163], v[64:67], v[12:15], 0
    v_mfma_f32_16x16x32_bf16 v[164:167], v[68:71], v[12:15], 0
    v_mfma_f32_16x16x32_bf16 v[168:171], v[72:75], v[12:15], 0
    v_mfma_f32_16x16x32_bf16 v[172:175], v[76:79], v[12:15], 0
    v_mfma_f32_16x16x32_bf16 v[176:179], v[80:83], v[12:15], 0
    v_mfma_f32_16x16x32_bf16 v[180:183], v[84:87], v[12:15], 0
    v_mfma_f32_16x16x32_bf16 v[184:187], v[88:91], v[12:15], 0
    v_mfma_f32_16x16x32_bf16 v[188:191], v[92:95], v[12:15], 0
    v_add_u32 v2, s31, v2
    s_add_u32 s29, s29, 64
    s_waitcnt vmcnt(0)
    v_add_u32 v0, s29, v5
    v_mfma_f32_16x16x32_bf16 v[192:195], v[96:99], v[12:15], 0
    ds_read_b128 v[16:19], v0
    v_mfma_f32_16x16x32_bf16 v[196:199], v[100:103], v[12:15], 0
    ds_read_b128 v[48:51], v2 offset:0
    v_mfma_f32_16x16x32_bf16 v[200:203], v[104:107], v[12:15], 0
    ds_read_b128 v[52:55], v2 offset:64
    v_mfma_f32_16x16x32_bf16 v[204:207], v[108:111], v[12:15], 0
    ds_read_b128 v[56:59], v2 offset:128
    v_mfma_f32_16x16x32_bf16 v[208:211], v[112:115], v[12:15], 0
    ds_read_b128 v[60:63], v2 offset:192
    v_mfma_f32_16x16x32_bf16 v[212:215], v[116:119], v[12:15], 0
    v_mfma_f32_16x16x32_bf16 v[216:219], v[120:123], v[12:15], 0
    v_mfma_f32_16x16x32_bf16 v[220:223], v[124:127], v[12:15], 0
    v_add_u32 v3, s31, v3
    v_add_u32 v4, s31, v4
    s_add_u32 s30, s30, s31
    s_sub_u32 s31, 0, s31
    s_add_u32 s28, s28, 1
    s_mov_b32 s52, 0
    s_branch MAIN_NEXT
TO_1_R1:
    s_waitcnt lgkmcnt(0)
    v_mfma_f32_16x16x32_bf16 v[28:31], v[60:63], v[156:159], v[28:31]
    v_cmp_eq_u32_sdwa s[32:33], v16, v7 src0_sel:BYTE_0 src1_sel:DWORD
    v_cmp_eq_u32_sdwa s[34:35], v17, v7 src0_sel:BYTE_0 src1_sel:DWORD
    v_cmp_eq_u32_sdwa s[36:37], v18, v7 src0_sel:BYTE_0 src1_sel:DWORD
    v_cmp_eq_u32_sdwa s[38:39], v19, v7 src0_sel:BYTE_0 src1_sel:DWORD
    s_nop 3
    v_pk_mul_f32 v[36:37], v[28:29], s[50:51] op_sel_hi:[1,0]
    v_pk_mul_f32 v[38:39], v[30:31], s[50:51] op_sel_hi:[1,0]
    v_max_f32 v36, v36, v28
    v_max_f32 v37, v37, v29
    v_max_f32 v38, v38, v30
    v_max_f32 v39, v39, v31
    v_exp_f32 v36, v36
    v_exp_f32 v37, v37
    v_exp_f32 v38, v38
    v_exp_f32 v39, v39
    v_cndmask_b32 v36, 0, v36, s[32:33]
    v_cndmask_b32 v37, 0, v37, s[34:35]
    v_cndmask_b32 v38, 0, v38, s[36:37]
    v_cndmask_b32 v39, 0, v39, s[38:39]
    v_cvt_pk_bf16_f32 v14, v36, v37
    v_cvt_pk_bf16_f32 v15, v38, v39
    s_nop 1
    v_mfma_f32_16x16x32_bf16 v[32:35], v[224:227], v[12:15], 0
    v_mfma_f32_16x16x32_bf16 v[160:163], v[64:67], v[12:15], 0
    v_mfma_f32_16x16x32_bf16 v[164:167], v[68:71], v[12:15], 0
    v_mfma_f32_16x16x32_bf16 v[168:171], v[72:75], v[12:15], 0
    v_mfma_f32_16x16x32_bf16 v[172:175], v[76:79], v[12:15], 0
    v_mfma_f32_16x16x32_bf16 v[176:179], v[80:83], v[12:15], 0
    v_mfma_f32_16x16x32_bf16 v[180:183], v[84:87], v[12:15], 0
    v_mfma_f32_16x16x32_bf16 v[184:187], v[88:91], v[12:15], 0
    v_mfma_f32_16x16x32_bf16 v[188:191], v[92:95], v[12:15], 0
    v_add_u32 v2, s31, v2
    s_add_u32 s29, s29, 64
    v_mfma_f32_16x16x32_bf16 v[192:195], v[96:99], v[12:15], 0
    v_mfma_f32_16x16x32_bf16 v[196:199], v[100:103], v[12:15], 0
    v_mfma_f32_16x16x32_bf16 v[200:203], v[104:107], v[12:15], 0
    v_mfma_f32_16x16x32_bf16 v[204:207], v[108:111], v[12:15], 0
    v_mfma_f32_16x16x32_bf16 v[208:211], v[112:115], v[12:15], 0
    v_mfma_f32_16x16x32_bf16 v[212:215], v[116:119], v[12:15], 0
    v_mfma_f32_16x16x32_bf16 v[216:219], v[120:123], v[12:15], 0
    v_mfma_f32_16x16x32_bf16 v[220:223], v[124:127], v[12:15], 0
    v_add_u32 v3, s31, v3
    v_add_u32 v4, s31, v4
    s_add_u32 s30, s30, s31
    s_sub_u32 s31, 0, s31
    s_add_u32 s28, s28, 1
    s_mov_b32 s52, 0
    s_branch MAIN_NEXT
MAIN_NEXT:
    s_branch MAIN_LOOP
MAIN_FINB:
    s_nop 3
    s_cmp_lg_u32 s26, 0
    s_cbranch_scc1 FB_25
    v_mov_b32 v160, 0
    v_mov_b32 v161, 0
    v_mov_b32 v162, 0
    v_mov_b32 v163, 0
    v_mov_b32 v164, 0
    v_mov_b32 v165, 0
    v_mov_b32 v166, 0
    v_mov_b32 v167, 0
    v_mov_b32 v168, 0
    v_mov_b32 v169, 0
    v_mov_b32 v170, 0
    v_mov_b32 v171, 0
    v_mov_b32 v172, 0
    v_mov_b32 v173, 0
    v_mov_b32 v174, 0
    v_mov_b32 v175, 0
    v_mov_b32 v176, 0
    v_mov_b32 v177, 0
    v_mov_b32 v178, 0
    v_mov_b32 v179, 0
    v_mov_b32 v180, 0
    v_mov_b32 v181, 0
    v_mov_b32 v182, 0
    v_mov_b32 v183, 0
    v_mov_b32 v184, 0
    v_mov_b32 v185, 0
    v_mov_b32 v186, 0
    v_mov_b32 v187, 0
    v_mov_b32 v188, 0
    v_mov_b32 v189, 0
    v_mov_b32 v190, 0
    v_mov_b32 v191, 0
    v_mov_b32 v192, 0
    v_mov_b32 v193, 0
    v_mov_b32 v194, 0
    v_mov_b32 v195, 0
    v_mov_b32 v196, 0
    v_mov_b32 v197, 0
    v_mov_b32 v198, 0
    v_mov_b32 v199, 0
    v_mov_b32 v200, 0
    v_mov_b32 v201, 0
    v_mov_b32 v202, 0
    v_mov_b32 v203, 0
    v_mov_b32 v204, 0
    v_mov_b32 v205, 0
    v_mov_b32 v206, 0
    v_mov_b32 v207, 0
    v_mov_b32 v208, 0
    v_mov_b32 v209, 0
    v_mov_b32 v210, 0
    v_mov_b32 v211, 0
    v_mov_b32 v212, 0
    v_mov_b32 v213, 0
    v_mov_b32 v214, 0
    v_mov_b32 v215, 0
    v_mov_b32 v216, 0
    v_mov_b32 v217, 0
    v_mov_b32 v218, 0
    v_mov_b32 v219, 0
    v_mov_b32 v220, 0
    v_mov_b32 v221, 0
    v_mov_b32 v222, 0
    v_mov_b32 v223, 0
    v_mov_b32 v32, 0
    v_mov_b32 v33, 0
    v_mov_b32 v34, 0
    v_mov_b32 v35, 0
FB_25:
    v_add_f32 v36, 0x3089705f, v32
    v_rcp_f32 v36, v36
    v_cndmask_b32 v160, v160, v176, s[70:71]
    v_mul_f32 v36, 0x3e800000, v36
    v_cndmask_b32 v161, v161, v177, s[70:71]
    v_cndmask_b32 v162, v162, v178, s[70:71]
    v_cndmask_b32 v163, v163, v179, s[70:71]
    v_cndmask_b32 v164, v164, v180, s[70:71]
    v_cndmask_b32 v165, v165, v181, s[70:71]
    v_cndmask_b32 v166, v166, v182, s[70:71]
    v_cndmask_b32 v167, v167, v183, s[70:71]
    v_cndmask_b32 v168, v168, v184, s[70:71]
    v_cndmask_b32 v169, v169, v185, s[70:71]
    v_cndmask_b32 v170, v170, v186, s[70:71]
    v_cndmask_b32 v171, v171, v187, s[70:71]
    v_cndmask_b32 v172, v172, v188, s[70:71]
    v_cndmask_b32 v173, v173, v189, s[70:71]
    v_cndmask_b32 v174, v174, v190, s[70:71]
    v_cndmask_b32 v175, v175, v191, s[70:71]
    v_cndmask_b32 v160, v160, v192, s[72:73]
    v_cndmask_b32 v161, v161, v193, s[72:73]
    v_cndmask_b32 v162, v162, v194, s[72:73]
    v_cndmask_b32 v163, v163, v195, s[72:73]
    v_cndmask_b32 v164, v164, v196, s[72:73]
    v_cndmask_b32 v165, v165, v197, s[72:73]
    v_cndmask_b32 v166, v166, v198, s[72:73]
    v_cndmask_b32 v167, v167, v199, s[72:73]
    v_cndmask_b32 v168, v168, v200, s[72:73]
    v_cndmask_b32 v169, v169, v201, s[72:73]
    v_cndmask_b32 v170, v170, v202, s[72:73]
    v_cndmask_b32 v171, v171, v203, s[72:73]
    v_cndmask_b32 v172, v172, v204, s[72:73]
    v_cndmask_b32 v173, v173, v205, s[72:73]
    v_cndmask_b32 v174, v174, v206, s[72:73]
    v_cndmask_b32 v175, v175, v207, s[72:73]
    v_cndmask_b32 v160, v160, v208, s[74:75]
    v_cndmask_b32 v161, v161, v209, s[74:75]
    v_cndmask_b32 v162, v162, v210, s[74:75]
    v_cndmask_b32 v163, v163, v211, s[74:75]
    v_cndmask_b32 v164, v164, v212, s[74:75]
    v_cndmask_b32 v165, v165, v213, s[74:75]
    v_cndmask_b32 v166, v166, v214, s[74:75]
    v_cndmask_b32 v167, v167, v215, s[74:75]
    v_cndmask_b32 v168, v168, v216, s[74:75]
    v_cndmask_b32 v169, v169, v217, s[74:75]
    v_cndmask_b32 v170, v170, v218, s[74:75]
    v_cndmask_b32 v171, v171, v219, s[74:75]
    v_cndmask_b32 v172, v172, v220, s[74:75]
    v_cndmask_b32 v173, v173, v221, s[74:75]
    v_cndmask_b32 v174, v174, v222, s[74:75]
    v_cndmask_b32 v175, v175, v223, s[74:75]
    v_pk_mul_f32 v[160:161], v[160:161], v[36:37] op_sel_hi:[1,0]
    v_pk_mul_f32 v[162:163], v[162:163], v[36:37] op_sel_hi:[1,0]
    v_pk_mul_f32 v[164:165], v[164:165], v[36:37] op_sel_hi:[1,0]
    v_pk_mul_f32 v[166:167], v[166:167], v[36:37] op_sel_hi:[1,0]
    v_pk_mul_f32 v[168:169], v[168:169], v[36:37] op_sel_hi:[1,0]
    v_pk_mul_f32 v[170:171], v[170:171], v[36:37] op_sel_hi:[1,0]
    v_pk_mul_f32 v[172:173], v[172:173], v[36:37] op_sel_hi:[1,0]
    v_pk_mul_f32 v[174:175], v[174:175], v[36:37] op_sel_hi:[1,0]
    v_cvt_pk_bf16_f32 v64, v160, v161
    v_cvt_pk_bf16_f32 v65, v162, v163
    v_cvt_pk_bf16_f32 v66, v164, v165
    v_cvt_pk_bf16_f32 v67, v166, v167
    v_cvt_pk_bf16_f32 v68, v168, v169
    v_cvt_pk_bf16_f32 v69, v170, v171
    v_cvt_pk_bf16_f32 v70, v172, v173
    v_cvt_pk_bf16_f32 v71, v174, v175
    ds_write_b128 v46, v[64:67]
    ds_write_b128 v47, v[68:71] offset:64
    v_mov_b32 v7, v40
    v_mov_b32 v8, v41
    v_mov_b32 v9, v41
    v_mov_b32 v10, v41
    v_mov_b32 v11, v41
    v_mbcnt_lo_u32_b32 v44, -1, 0
    v_mbcnt_hi_u32_b32 v44, -1, v44
    v_and_b32 v38, 15, v44
    v_lshrrev_b32 v39, 4, v44
    s_and_b32 s41, s24, 1
    s_lshl_b32 s41, s41, 7
    s_add_u32 s41, s41, s45
    v_lshrrev_b32 v46, 2, v38
    v_mul_u32_u24 v46, 2080, v46
    v_add_u32 v46, s41, v46
    v_and_b32 v42, 3, v38
    v_lshl_add_u32 v46, v42, 9, v46
    v_and_b32 v43, 1, v42
    v_xor_b32 v43, v43, v39
    v_lshl_add_u32 v46, v43, 4, v46
    v_lshrrev_b32 v42, 1, v42
    v_lshlrev_b32 v42, 6, v42
    v_sub_u32 v47, v46, v42
    v_add_u32 v46, v46, v42
    s_mov_b32 s52, 1
    s_waitcnt lgkmcnt(0)
    s_branch MAIN_LOOP2
MAIN_DONE:
    s_setprio 0
    s_cmp_lg_u32 s25, 0
    s_cbranch_scc1 MAIN_DONE2
    v_mov_b32 v160, 0
    v_mov_b32 v161, 0
    v_mov_b32 v162, 0
    v_mov_b32 v163, 0
    v_mov_b32 v164, 0
    v_mov_b32 v165, 0
    v_mov_b32 v166, 0
    v_mov_b32 v167, 0
    v_mov_b32 v168, 0
    v_mov_b32 v169, 0
    v_mov_b32 v170, 0
    v_mov_b32 v171, 0
    v_mov_b32 v172, 0
    v_mov_b32 v173, 0
    v_mov_b32 v174, 0
    v_mov_b32 v175, 0
    v_mov_b32 v176, 0
    v_mov_b32 v177, 0
    v_mov_b32 v178, 0
    v_mov_b32 v179, 0
    v_mov_b32 v180, 0
    v_mov_b32 v181, 0
    v_mov_b32 v182, 0
    v_mov_b32 v183, 0
    v_mov_b32 v184, 0
    v_mov_b32 v185, 0
    v_mov_b32 v186, 0
    v_mov_b32 v187, 0
    v_mov_b32 v188, 0
    v_mov_b32 v189, 0
    v_mov_b32 v190, 0
    v_mov_b32 v191, 0
    v_mov_b32 v192, 0
    v_mov_b32 v193, 0
    v_mov_b32 v194, 0
    v_mov_b32 v195, 0
    v_mov_b32 v196, 0
    v_mov_b32 v197, 0
    v_mov_b32 v198, 0
    v_mov_b32 v199, 0
    v_mov_b32 v200, 0
    v_mov_b32 v201, 0
    v_mov_b32 v202, 0
    v_mov_b32 v203, 0
    v_mov_b32 v204, 0
    v_mov_b32 v205, 0
    v_mov_b32 v206, 0
    v_mov_b32 v207, 0
    v_mov_b32 v208, 0
    v_mov_b32 v209, 0
    v_mov_b32 v210, 0
    v_mov_b32 v211, 0
    v_mov_b32 v212, 0
    v_mov_b32 v213, 0
    v_mov_b32 v214, 0
    v_mov_b32 v215, 0
    v_mov_b32 v216, 0
    v_mov_b32 v217, 0
    v_mov_b32 v218, 0
    v_mov_b32 v219, 0
    v_mov_b32 v220, 0
    v_mov_b32 v221, 0
    v_mov_b32 v222, 0
    v_mov_b32 v223, 0
    v_mov_b32 v32, 0
    v_mov_b32 v33, 0
    v_mov_b32 v34, 0
    v_mov_b32 v35, 0
MAIN_DONE2:
    v_mbcnt_lo_u32_b32 v42, -1, 0
    v_mbcnt_hi_u32_b32 v42, -1, v42
    v_and_b32 v43, 15, v42
    v_lshrrev_b32 v44, 4, v42
    v_lshrrev_b32 v0, 2, v43
    v_mul_u32_u24 v1, 17408, v0
    v_and_b32 v0, 1, v0
    v_lshl_add_u32 v1, v0, 7, v1
    v_and_b32 v0, 3, v43
    v_mul_u32_u24 v0, 2080, v0
    v_add_u32 v1, v1, v0
    v_and_b32 v0, 7, v43
    v_mul_u32_u24 v5, 2080, v0
    v_add_u32 v5, 139264, v5
    v_lshlrev_b32 v0, 4, v44
    v_xor_b32 v42, 16, v0
    v_add_u32 v2, v1, v42
    v_add_u32 v1, v1, v0
    v_add_u32 v3, 69632, v1
    v_add_u32 v4, 69632, v2
    v_add_u32 v6, v5, v42
    v_add_u32 v5, v5, v0
    s_mul_i32 s41, s2, 20480
    s_lshl_b32 s42, s24, 6
    s_add_u32 s41, s41, s42
    v_lshlrev_b32 v8, 9, v43
    v_lshl_add_u32 v8, v44, 4, v8
    v_add_u32 v8, s41, v8
    v_add_u32 v9, 8192, v8
    v_add_u32 v10, 16384, v8
    v_mov_b32 v0, 0x7ffffff0
    v_cmp_gt_u32 vcc, 8, v43
    v_mov_b32 v7, v45
    s_nop 0
    s_mov_b64 s[48:49], vcc
    v_cndmask_b32 v10, v0, v10, vcc
    v_add_f32 v36, 0x3089705f, v32
    v_rcp_f32 v36, v36
    s_nop 0
    v_mul_f32 v36, 0x3e800000, v36
    v_pk_mul_f32 v[160:161], v[160:161], v[36:37] op_sel_hi:[1,0]
    v_pk_mul_f32 v[162:163], v[162:163], v[36:37] op_sel_hi:[1,0]
    v_pk_mul_f32 v[164:165], v[164:165], v[36:37] op_sel_hi:[1,0]
    v_pk_mul_f32 v[166:167], v[166:167], v[36:37] op_sel_hi:[1,0]
    v_cvt_pk_bf16_f32 v12, v160, v161
    v_cvt_pk_bf16_f32 v13, v162, v163
    v_cvt_pk_bf16_f32 v14, v164, v165
    v_cvt_pk_bf16_f32 v15, v166, v167
    ds_write_b128 v46, v[12:15] offset:0
    s_add_u32 s41, s47, 4096
    buffer_load_dwordx4 v[248:251], v7, s[8:11], s41 offen
    buffer_load_dwordx4 v[252:255], v7, s[8:11], s41 offen offset:1024
    v_pk_mul_f32 v[168:169], v[168:169], v[36:37] op_sel_hi:[1,0]
    v_pk_mul_f32 v[170:171], v[170:171], v[36:37] op_sel_hi:[1,0]
    v_pk_mul_f32 v[172:173], v[172:173], v[36:37] op_sel_hi:[1,0]
    v_pk_mul_f32 v[174:175], v[174:175], v[36:37] op_sel_hi:[1,0]
    v_cvt_pk_bf16_f32 v16, v168, v169
    v_cvt_pk_bf16_f32 v17, v170, v171
    v_cvt_pk_bf16_f32 v18, v172, v173
    v_cvt_pk_bf16_f32 v19, v174, v175
    ds_write_b128 v47, v[16:19] offset:64
    s_add_u32 s41, s47, 6144
    buffer_load_dwordx4 v[64:67], v7, s[8:11], s41 offen
    buffer_load_dwordx4 v[68:71], v7, s[8:11], s41 offen offset:1024
    v_pk_mul_f32 v[176:177], v[176:177], v[36:37] op_sel_hi:[1,0]
    v_pk_mul_f32 v[178:179], v[178:179], v[36:37] op_sel_hi:[1,0]
    v_pk_mul_f32 v[180:181], v[180:181], v[36:37] op_sel_hi:[1,0]
    v_pk_mul_f32 v[182:183], v[182:183], v[36:37] op_sel_hi:[1,0]
    v_cvt_pk_bf16_f32 v20, v176, v177
    v_cvt_pk_bf16_f32 v21, v178, v179
    v_cvt_pk_bf16_f32 v22, v180, v181
    v_cvt_pk_bf16_f32 v23, v182, v183
    ds_write_b128 v46, v[20:23] offset:128
    s_add_u32 s41, s47, 8192
    buffer_load_dwordx4 v[72:75], v7, s[8:11], s41 offen
    buffer_load_dwordx4 v[76:79], v7, s[8:11], s41 offen offset:1024
    v_pk_mul_f32 v[184:185], v[184:185], v[36:37] op_sel_hi:[1,0]
    v_pk_mul_f32 v[186:187], v[186:187], v[36:37] op_sel_hi:[1,0]
    v_pk_mul_f32 v[188:189], v[188:189], v[36:37] op_sel_hi:[1,0]
    v_pk_mul_f32 v[190:191], v[190:191], v[36:37] op_sel_hi:[1,0]
    v_cvt_pk_bf16_f32 v24, v184, v185
    v_cvt_pk_bf16_f32 v25, v186, v187
    v_cvt_pk_bf16_f32 v26, v188, v189
    v_cvt_pk_bf16_f32 v27, v190, v191
    ds_write_b128 v47, v[24:27] offset:192
    s_add_u32 s41, s47, 10240
    buffer_load_dwordx4 v[80:83], v7, s[8:11], s41 offen
    buffer_load_dwordx4 v[84:87], v7, s[8:11], s41 offen offset:1024
    s_add_u32 s41, s47, 12288
    buffer_load_dwordx4 v[88:91], v7, s[8:11], s41 offen
    buffer_load_dwordx4 v[92:95], v7, s[8:11], s41 offen offset:1024
    v_pk_mul_f32 v[192:193], v[192:193], v[36:37] op_sel_hi:[1,0]
    v_pk_mul_f32 v[194:195], v[194:195], v[36:37] op_sel_hi:[1,0]
    v_pk_mul_f32 v[196:197], v[196:197], v[36:37] op_sel_hi:[1,0]
    v_pk_mul_f32 v[198:199], v[198:199], v[36:37] op_sel_hi:[1,0]
    v_cvt_pk_bf16_f32 v12, v192, v193
    v_cvt_pk_bf16_f32 v13, v194, v195
    v_cvt_pk_bf16_f32 v14, v196, v197
    v_cvt_pk_bf16_f32 v15, v198, v199
    ds_write_b128 v46, v[12:15] offset:256
    s_add_u32 s41, s47, 14336
    buffer_load_dwordx4 v[96:99], v7, s[8:11], s41 offen
    buffer_load_dwordx4 v[100:103], v7, s[8:11], s41 offen offset:1024
    v_pk_mul_f32 v[200:201], v[200:201], v[36:37] op_sel_hi:[1,0]
    v_pk_mul_f32 v[202:203], v[202:203], v[36:37] op_sel_hi:[1,0]
    v_pk_mul_f32 v[204:205], v[204:205], v[36:37] op_sel_hi:[1,0]
    v_pk_mul_f32 v[206:207], v[206:207], v[36:37] op_sel_hi:[1,0]
    v_cvt_pk_bf16_f32 v16, v200, v201
    v_cvt_pk_bf16_f32 v17, v202, v203
    v_cvt_pk_bf16_f32 v18, v204, v205
    v_cvt_pk_bf16_f32 v19, v206, v207
    ds_write_b128 v47, v[16:19] offset:320
    s_add_u32 s41, s47, 16384
    buffer_load_dwordx4 v[104:107], v7, s[8:11], s41 offen
    buffer_load_dwordx4 v[108:111], v7, s[8:11], s41 offen offset:1024
    v_pk_mul_f32 v[208:209], v[208:209], v[36:37] op_sel_hi:[1,0]
    v_pk_mul_f32 v[210:211], v[210:211], v[36:37] op_sel_hi:[1,0]
    v_pk_mul_f32 v[212:213], v[212:213], v[36:37] op_sel_hi:[1,0]
    v_pk_mul_f32 v[214:215], v[214:215], v[36:37] op_sel_hi:[1,0]
    v_cvt_pk_bf16_f32 v20, v208, v209
    v_cvt_pk_bf16_f32 v21, v210, v211
    v_cvt_pk_bf16_f32 v22, v212, v213
    v_cvt_pk_bf16_f32 v23, v214, v215
    ds_write_b128 v46, v[20:23] offset:384
    s_add_u32 s41, s47, 18432
    buffer_load_dwordx4 v[112:115], v7, s[8:11], s41 offen
    buffer_load_dwordx4 v[116:119], v7, s[8:11], s41 offen offset:1024
    v_pk_mul_f32 v[216:217], v[216:217], v[36:37] op_sel_hi:[1,0]
    v_pk_mul_f32 v[218:219], v[218:219], v[36:37] op_sel_hi:[1,0]
    v_pk_mul_f32 v[220:221], v[220:221], v[36:37] op_sel_hi:[1,0]
    v_pk_mul_f32 v[222:223], v[222:223], v[36:37] op_sel_hi:[1,0]
    v_cvt_pk_bf16_f32 v24, v216, v217
    v_cvt_pk_bf16_f32 v25, v218, v219
    v_cvt_pk_bf16_f32 v26, v220, v221
    v_cvt_pk_bf16_f32 v27, v222, v223
    ds_write_b128 v47, v[24:27] offset:448
    s_add_u32 s41, s47, 20480
    buffer_load_dwordx4 v[120:123], v7, s[8:11], s41 offen
    buffer_load_dwordx4 v[124:127], v7, s[8:11], s41 offen offset:1024
    s_add_u32 s41, s47, 22528
    buffer_load_dwordx4 v[128:131], v7, s[8:11], s41 offen
    buffer_load_dwordx4 v[132:135], v7, s[8:11], s41 offen offset:1024
    s_waitcnt lgkmcnt(0)
    s_barrier
    v_mov_b32 v168, 0
    v_mov_b32 v169, 0
    v_mov_b32 v170, 0
    v_mov_b32 v171, 0
    v_mov_b32 v180, 0
    v_mov_b32 v181, 0
    v_mov_b32 v182, 0
    v_mov_b32 v183, 0
    v_mov_b32 v192, 0
    v_mov_b32 v193, 0
    v_mov_b32 v194, 0
    v_mov_b32 v195, 0
    v_mov_b32 v204, 0
    v_mov_b32 v205, 0
    v_mov_b32 v206, 0
    v_mov_b32 v207, 0
    ds_read_b128 v[160:163], v1 offset:0
    ds_read_b128 v[164:167], v3 offset:0
    s_mov_b64 exec, s[48:49]
    ds_read_b128 v[168:171], v5 offset:0
    s_mov_b64 exec, -1
    ds_read_b128 v[172:175], v1 offset:64
    ds_read_b128 v[176:179], v3 offset:64
    s_mov_b64 exec, s[48:49]
    ds_read_b128 v[180:183], v5 offset:64
    s_mov_b64 exec, -1
    ds_read_b128 v[184:187], v1 offset:128
    ds_read_b128 v[188:191], v3 offset:128
    s_mov_b64 exec, s[48:49]
    ds_read_b128 v[192:195], v5 offset:128
    s_mov_b64 exec, -1
    s_cmp_lt_u32 s24, 4
    s_cbranch_scc1 GP_26
    s_setprio 1
GP_26:
    ds_read_b128 v[196:199], v1 offset:192
    ds_read_b128 v[200:203], v3 offset:192
    s_mov_b64 exec, s[48:49]
    ds_read_b128 v[204:207], v5 offset:192
    s_mov_b64 exec, -1
    s_waitcnt vmcnt(22) lgkmcnt(9)
    v_mfma_f32_16x16x32_bf16 v[40:43], v[232:235], v[160:163], 0
    v_mfma_f32_16x16x32_bf16 v[44:47], v[236:239], v[160:163], 0
    v_mfma_f32_16x16x32_bf16 v[48:51], v[232:235], v[164:167], 0
    v_mfma_f32_16x16x32_bf16 v[52:55], v[236:239], v[164:167], 0
    v_mfma_f32_16x16x32_bf16 v[56:59], v[232:235], v[168:171], 0
    v_mfma_f32_16x16x32_bf16 v[60:63], v[236:239], v[168:171], 0
    s_add_u32 s41, s47, 24576
    buffer_load_dwordx4 v[136:139], v7, s[8:11], s41 offen
    buffer_load_dwordx4 v[140:143], v7, s[8:11], s41 offen offset:1024
    ds_read_b128 v[160:163], v1 offset:256
    ds_read_b128 v[164:167], v3 offset:256
    s_mov_b64 exec, s[48:49]
    ds_read_b128 v[168:171], v5 offset:256
    s_mov_b64 exec, -1
    s_waitcnt vmcnt(22) lgkmcnt(9)
    v_mfma_f32_16x16x32_bf16 v[40:43], v[240:243], v[172:175], v[40:43]
    v_mfma_f32_16x16x32_bf16 v[44:47], v[244:247], v[172:175], v[44:47]
    v_mfma_f32_16x16x32_bf16 v[48:51], v[240:243], v[176:179], v[48:51]
    v_mfma_f32_16x16x32_bf16 v[52:55], v[244:247], v[176:179], v[52:55]
    v_mfma_f32_16x16x32_bf16 v[56:59], v[240:243], v[180:183], v[56:59]
    v_mfma_f32_16x16x32_bf16 v[60:63], v[244:247], v[180:183], v[60:63]
    s_add_u32 s41, s47, 26624
    buffer_load_dwordx4 v[144:147], v7, s[8:11], s41 offen
    buffer_load_dwordx4 v[148:151], v7, s[8:11], s41 offen offset:1024
    ds_read_b128 v[172:175], v1 offset:320
    ds_read_b128 v[176:179], v3 offset:320
    s_mov_b64 exec, s[48:49]
    ds_read_b128 v[180:183], v5 offset:320
    s_mov_b64 exec, -1
    s_waitcnt vmcnt(22) lgkmcnt(9)
    v_mfma_f32_16x16x32_bf16 v[40:43], v[248:251], v[184:187], v[40:43]
    v_mfma_f32_16x16x32_bf16 v[44:47], v[252:255], v[184:187], v[44:47]
    v_mfma_f32_16x16x32_bf16 v[48:51], v[248:251], v[188:191], v[48:51]
    v_mfma_f32_16x16x32_bf16 v[52:55], v[252:255], v[188:191], v[52:55]
    v_mfma_f32_16x16x32_bf16 v[56:59], v[248:251], v[192:195], v[56:59]
    v_mfma_f32_16x16x32_bf16 v[60:63], v[252:255], v[192:195], v[60:63]
    s_add_u32 s41, s47, 28672
    buffer_load_dwordx4 v[152:155], v7, s[8:11], s41 offen
    buffer_load_dwordx4 v[156:159], v7, s[8:11], s41 offen offset:1024
    ds_read_b128 v[184:187], v1 offset:384
    ds_read_b128 v[188:191], v3 offset:384
    s_mov_b64 exec, s[48:49]
    ds_read_b128 v[192:195], v5 offset:384
    s_mov_b64 exec, -1
    s_waitcnt vmcnt(22) lgkmcnt(9)
    v_mfma_f32_16x16x32_bf16 v[40:43], v[64:67], v[196:199], v[40:43]
    v_mfma_f32_16x16x32_bf16 v[44:47], v[68:71], v[196:199], v[44:47]
    v_mfma_f32_16x16x32_bf16 v[48:51], v[64:67], v[200:203], v[48:51]
    v_mfma_f32_16x16x32_bf16 v[52:55], v[68:71], v[200:203], v[52:55]
    v_mfma_f32_16x16x32_bf16 v[56:59], v[64:67], v[204:207], v[56:59]
    v_mfma_f32_16x16x32_bf16 v[60:63], v[68:71], v[204:207], v[60:63]
    s_add_u32 s41, s47, 30720
    buffer_load_dwordx4 v[224:227], v7, s[8:11], s41 offen
    buffer_load_dwordx4 v[228:231], v7, s[8:11], s41 offen offset:1024
    ds_read_b128 v[196:199], v1 offset:448
    ds_read_b128 v[200:203], v3 offset:448
    s_mov_b64 exec, s[48:49]
    ds_read_b128 v[204:207], v5 offset:448
    s_mov_b64 exec, -1
    s_waitcnt vmcnt(22) lgkmcnt(9)
    v_mfma_f32_16x16x32_bf16 v[40:43], v[72:75], v[160:163], v[40:43]
    v_mfma_f32_16x16x32_bf16 v[44:47], v[76:79], v[160:163], v[44:47]
    v_mfma_f32_16x16x32_bf16 v[48:51], v[72:75], v[164:167], v[48:51]
    v_mfma_f32_16x16x32_bf16 v[52:55], v[76:79], v[164:167], v[52:55]
    v_mfma_f32_16x16x32_bf16 v[56:59], v[72:75], v[168:171], v[56:59]
    v_mfma_f32_16x16x32_bf16 v[60:63], v[76:79], v[168:171], v[60:63]
    ds_read_b128 v[160:163], v2 offset:512
    ds_read_b128 v[164:167], v4 offset:512
    s_mov_b64 exec, s[48:49]
    ds_read_b128 v[168:171], v6 offset:512
    s_mov_b64 exec, -1
    s_waitcnt vmcnt(20) lgkmcnt(9)
    v_mfma_f32_16x16x32_bf16 v[40:43], v[80:83], v[172:175], v[40:43]
    v_mfma_f32_16x16x32_bf16 v[44:47], v[84:87], v[172:175], v[44:47]
    v_mfma_f32_16x16x32_bf16 v[48:51], v[80:83], v[176:179], v[48:51]
    v_mfma_f32_16x16x32_bf16 v[52:55], v[84:87], v[176:179], v[52:55]
    v_mfma_f32_16x16x32_bf16 v[56:59], v[80:83], v[180:183], v[56:59]
    v_mfma_f32_16x16x32_bf16 v[60:63], v[84:87], v[180:183], v[60:63]
    s_add_u32 s41, s47, 32768
    buffer_load_dwordx4 v[232:235], v7, s[8:11], s41 offen
    buffer_load_dwordx4 v[236:239], v7, s[8:11], s41 offen offset:1024
    ds_read_b128 v[172:175], v2 offset:576
    ds_read_b128 v[176:179], v4 offset:576
    s_mov_b64 exec, s[48:49]
    ds_read_b128 v[180:183], v6 offset:576
    s_mov_b64 exec, -1
    s_waitcnt vmcnt(20) lgkmcnt(9)
    v_mfma_f32_16x16x32_bf16 v[40:43], v[88:91], v[184:187], v[40:43]
    v_mfma_f32_16x16x32_bf16 v[44:47], v[92:95], v[184:187], v[44:47]
    v_mfma_f32_16x16x32_bf16 v[48:51], v[88:91], v[188:191], v[48:51]
    v_mfma_f32_16x16x32_bf16 v[52:55], v[92:95], v[188:191], v[52:55]
    v_mfma_f32_16x16x32_bf16 v[56:59], v[88:91], v[192:195], v[56:59]
    v_mfma_f32_16x16x32_bf16 v[60:63], v[92:95], v[192:195], v[60:63]
    s_add_u32 s41, s47, 34816
    buffer_load_dwordx4 v[240:243], v7, s[8:11], s41 offen
    buffer_load_dwordx4 v[244:247], v7, s[8:11], s41 offen offset:1024
    ds_read_b128 v[184:187], v2 offset:640
    ds_read_b128 v[188:191], v4 offset:640
    s_mov_b64 exec, s[48:49]
    ds_read_b128 v[192:195], v6 offset:640
    s_mov_b64 exec, -1
    s_waitcnt vmcnt(20) lgkmcnt(9)
    v_mfma_f32_16x16x32_bf16 v[40:43], v[96:99], v[196:199], v[40:43]
    v_mfma_f32_16x16x32_bf16 v[44:47], v[100:103], v[196:199], v[44:47]
    v_mfma_f32_16x16x32_bf16 v[48:51], v[96:99], v[200:203], v[48:51]
    v_mfma_f32_16x16x32_bf16 v[52:55], v[100:103], v[200:203], v[52:55]
    v_mfma_f32_16x16x32_bf16 v[56:59], v[96:99], v[204:207], v[56:59]
    v_mfma_f32_16x16x32_bf16 v[60:63], v[100:103], v[204:207], v[60:63]
    s_add_u32 s41, s47, 36864
    buffer_load_dwordx4 v[248:251], v7, s[8:11], s41 offen
    buffer_load_dwordx4 v[252:255], v7, s[8:11], s41 offen offset:1024
    ds_read_b128 v[196:199], v2 offset:704
    ds_read_b128 v[200:203], v4 offset:704
    s_mov_b64 exec, s[48:49]
    ds_read_b128 v[204:207], v6 offset:704
    s_mov_b64 exec, -1
    s_waitcnt vmcnt(20) lgkmcnt(9)
    v_mfma_f32_16x16x32_bf16 v[40:43], v[104:107], v[160:163], v[40:43]
    v_mfma_f32_16x16x32_bf16 v[44:47], v[108:111], v[160:163], v[44:47]
    v_mfma_f32_16x16x32_bf16 v[48:51], v[104:107], v[164:167], v[48:51]
    v_mfma_f32_16x16x32_bf16 v[52:55], v[108:111], v[164:167], v[52:55]
    v_mfma_f32_16x16x32_bf16 v[56:59], v[104:107], v[168:171], v[56:59]
    v_mfma_f32_16x16x32_bf16 v[60:63], v[108:111], v[168:171], v[60:63]
    s_add_u32 s41, s47, 38912
    buffer_load_dwordx4 v[64:67], v7, s[8:11], s41 offen
    buffer_load_dwordx4 v[68:71], v7, s[8:11], s41 offen offset:1024
    ds_read_b128 v[160:163], v2 offset:768
    ds_read_b128 v[164:167], v4 offset:768
    s_mov_b64 exec, s[48:49]
    ds_read_b128 v[168:171], v6 offset:768
    s_mov_b64 exec, -1
    s_waitcnt vmcnt(20) lgkmcnt(9)
    v_mfma_f32_16x16x32_bf16 v[40:43], v[112:115], v[172:175], v[40:43]
    v_mfma_f32_16x16x32_bf16 v[44:47], v[116:119], v[172:175], v[44:47]
    v_mfma_f32_16x16x32_bf16 v[48:51], v[112:115], v[176:179], v[48:51]
    v_mfma_f32_16x16x32_bf16 v[52:55], v[116:119], v[176:179], v[52:55]
    v_mfma_f32_16x16x32_bf16 v[56:59], v[112:115], v[180:183], v[56:59]
    v_mfma_f32_16x16x32_bf16 v[60:63], v[116:119], v[180:183], v[60:63]
    ds_read_b128 v[172:175], v2 offset:832
    ds_read_b128 v[176:179], v4 offset:832
    s_mov_b64 exec, s[48:49]
    ds_read_b128 v[180:183], v6 offset:832
    s_mov_b64 exec, -1
    s_waitcnt vmcnt(18) lgkmcnt(9)
    v_mfma_f32_16x16x32_bf16 v[40:43], v[120:123], v[184:187], v[40:43]
    v_mfma_f32_16x16x32_bf16 v[44:47], v[124:127], v[184:187], v[44:47]
    v_mfma_f32_16x16x32_bf16 v[48:51], v[120:123], v[188:191], v[48:51]
    v_mfma_f32_16x16x32_bf16 v[52:55], v[124:127], v[188:191], v[52:55]
    v_mfma_f32_16x16x32_bf16 v[56:59], v[120:123], v[192:195], v[56:59]
    v_mfma_f32_16x16x32_bf16 v[60:63], v[124:127], v[192:195], v[60:63]
    s_add_u32 s41, s47, 40960
    buffer_load_dwordx4 v[72:75], v7, s[8:11], s41 offen
    buffer_load_dwordx4 v[76:79], v7, s[8:11], s41 offen offset:1024
    ds_read_b128 v[184:187], v2 offset:896
    ds_read_b128 v[188:191], v4 offset:896
    s_mov_b64 exec, s[48:49]
    ds_read_b128 v[192:195], v6 offset:896
    s_mov_b64 exec, -1
    s_waitcnt vmcnt(18) lgkmcnt(9)
    v_mfma_f32_16x16x32_bf16 v[40:43], v[128:131], v[196:199], v[40:43]
    v_mfma_f32_16x16x32_bf16 v[44:47], v[132:135], v[196:199], v[44:47]
    v_mfma_f32_16x16x32_bf16 v[48:51], v[128:131], v[200:203], v[48:51]
    v_mfma_f32_16x16x32_bf16 v[52:55], v[132:135], v[200:203], v[52:55]
    v_mfma_f32_16x16x32_bf16 v[56:59], v[128:131], v[204:207], v[56:59]
    v_mfma_f32_16x16x32_bf16 v[60:63], v[132:135], v[204:207], v[60:63]
    s_add_u32 s41, s47, 43008
    buffer_load_dwordx4 v[80:83], v7, s[8:11], s41 offen
    buffer_load_dwordx4 v[84:87], v7, s[8:11], s41 offen offset:1024
    ds_read_b128 v[196:199], v2 offset:960
    ds_read_b128 v[200:203], v4 offset:960
    s_mov_b64 exec, s[48:49]
    ds_read_b128 v[204:207], v6 offset:960
    s_mov_b64 exec, -1
    s_waitcnt vmcnt(18) lgkmcnt(9)
    v_mfma_f32_16x16x32_bf16 v[40:43], v[136:139], v[160:163], v[40:43]
    v_mfma_f32_16x16x32_bf16 v[44:47], v[140:143], v[160:163], v[44:47]
    v_mfma_f32_16x16x32_bf16 v[48:51], v[136:139], v[164:167], v[48:51]
    v_mfma_f32_16x16x32_bf16 v[52:55], v[140:143], v[164:167], v[52:55]
    v_mfma_f32_16x16x32_bf16 v[56:59], v[136:139], v[168:171], v[56:59]
    v_mfma_f32_16x16x32_bf16 v[60:63], v[140:143], v[168:171], v[60:63]
    s_add_u32 s41, s47, 45056
    buffer_load_dwordx4 v[88:91], v7, s[8:11], s41 offen
    buffer_load_dwordx4 v[92:95], v7, s[8:11], s41 offen offset:1024
    s_cmp_lt_u32 s24, 4
    s_cbranch_scc0 GP_27
    s_setprio 1
GP_27:
    ds_read_b128 v[160:163], v1 offset:1088
    ds_read_b128 v[164:167], v3 offset:1088
    s_mov_b64 exec, s[48:49]
    ds_read_b128 v[168:171], v5 offset:1088
    s_mov_b64 exec, -1
    s_waitcnt vmcnt(18) lgkmcnt(9)
    v_mfma_f32_16x16x32_bf16 v[40:43], v[144:147], v[172:175], v[40:43]
    v_mfma_f32_16x16x32_bf16 v[44:47], v[148:151], v[172:175], v[44:47]
    v_mfma_f32_16x16x32_bf16 v[48:51], v[144:147], v[176:179], v[48:51]
    v_mfma_f32_16x16x32_bf16 v[52:55], v[148:151], v[176:179], v[52:55]
    v_mfma_f32_16x16x32_bf16 v[56:59], v[144:147], v[180:183], v[56:59]
    v_mfma_f32_16x16x32_bf16 v[60:63], v[148:151], v[180:183], v[60:63]
    s_add_u32 s41, s47, 47104
    buffer_load_dwordx4 v[96:99], v7, s[8:11], s41 offen
    buffer_load_dwordx4 v[100:103], v7, s[8:11], s41 offen offset:1024
    ds_read_b128 v[172:175], v1 offset:1024
    ds_read_b128 v[176:179], v3 offset:1024
    s_mov_b64 exec, s[48:49]
    ds_read_b128 v[180:183], v5 offset:1024
    s_mov_b64 exec, -1
    s_waitcnt vmcnt(18) lgkmcnt(9)
    v_mfma_f32_16x16x32_bf16 v[40:43], v[152:155], v[184:187], v[40:43]
    v_mfma_f32_16x16x32_bf16 v[44:47], v[156:159], v[184:187], v[44:47]
    v_mfma_f32_16x16x32_bf16 v[48:51], v[152:155], v[188:191], v[48:51]
    v_mfma_f32_16x16x32_bf16 v[52:55], v[156:159], v[188:191], v[52:55]
    v_mfma_f32_16x16x32_bf16 v[56:59], v[152:155], v[192:195], v[56:59]
    v_mfma_f32_16x16x32_bf16 v[60:63], v[156:159], v[192:195], v[60:63]
    ds_read_b128 v[184:187], v1 offset:1216
    ds_read_b128 v[188:191], v3 offset:1216
    s_mov_b64 exec, s[48:49]
    ds_read_b128 v[192:195], v5 offset:1216
    s_mov_b64 exec, -1
    s_waitcnt vmcnt(16) lgkmcnt(9)
    v_mfma_f32_16x16x32_bf16 v[40:43], v[224:227], v[196:199], v[40:43]
    v_mfma_f32_16x16x32_bf16 v[44:47], v[228:231], v[196:199], v[44:47]
    v_mfma_f32_16x16x32_bf16 v[48:51], v[224:227], v[200:203], v[48:51]
    v_mfma_f32_16x16x32_bf16 v[52:55], v[228:231], v[200:203], v[52:55]
    v_mfma_f32_16x16x32_bf16 v[56:59], v[224:227], v[204:207], v[56:59]
    v_mfma_f32_16x16x32_bf16 v[60:63], v[228:231], v[204:207], v[60:63]
    s_add_u32 s41, s47, 49152
    buffer_load_dwordx4 v[104:107], v7, s[8:11], s41 offen
    buffer_load_dwordx4 v[108:111], v7, s[8:11], s41 offen offset:1024
    ds_read_b128 v[196:199], v1 offset:1152
    ds_read_b128 v[200:203], v3 offset:1152
    s_mov_b64 exec, s[48:49]
    ds_read_b128 v[204:207], v5 offset:1152
    s_mov_b64 exec, -1
    s_waitcnt vmcnt(16) lgkmcnt(9)
    v_mfma_f32_16x16x32_bf16 v[40:43], v[232:235], v[160:163], v[40:43]
    v_mfma_f32_16x16x32_bf16 v[44:47], v[236:239], v[160:163], v[44:47]
    v_mfma_f32_16x16x32_bf16 v[48:51], v[232:235], v[164:167], v[48:51]
    v_mfma_f32_16x16x32_bf16 v[52:55], v[236:239], v[164:167], v[52:55]
    v_mfma_f32_16x16x32_bf16 v[56:59], v[232:235], v[168:171], v[56:59]
    v_mfma_f32_16x16x32_bf16 v[60:63], v[236:239], v[168:171], v[60:63]
    s_add_u32 s41, s47, 51200
    buffer_load_dwordx4 v[112:115], v7, s[8:11], s41 offen
    buffer_load_dwordx4 v[116:119], v7, s[8:11], s41 offen offset:1024
    ds_read_b128 v[160:163], v1 offset:1344
    ds_read_b128 v[164:167], v3 offset:1344
    s_mov_b64 exec, s[48:49]
    ds_read_b128 v[168:171], v5 offset:1344
    s_mov_b64 exec, -1
    s_waitcnt vmcnt(16) lgkmcnt(9)
    v_mfma_f32_16x16x32_bf16 v[40:43], v[240:243], v[172:175], v[40:43]
    v_mfma_f32_16x16x32_bf16 v[44:47], v[244:247], v[172:175], v[44:47]
    v_mfma_f32_16x16x32_bf16 v[48:51], v[240:243], v[176:179], v[48:51]
    v_mfma_f32_16x16x32_bf16 v[52:55], v[244:247], v[176:179], v[52:55]
    v_mfma_f32_16x16x32_bf16 v[56:59], v[240:243], v[180:183], v[56:59]
    v_mfma_f32_16x16x32_bf16 v[60:63], v[244:247], v[180:183], v[60:63]
    s_add_u32 s41, s47, 53248
    buffer_load_dwordx4 v[120:123], v7, s[8:11], s41 offen
    buffer_load_dwordx4 v[124:127], v7, s[8:11], s41 offen offset:1024
    ds_read_b128 v[172:175], v1 offset:1280
    ds_read_b128 v[176:179], v3 offset:1280
    s_mov_b64 exec, s[48:49]
    ds_read_b128 v[180:183], v5 offset:1280
    s_mov_b64 exec, -1
    s_waitcnt vmcnt(16) lgkmcnt(9)
    v_mfma_f32_16x16x32_bf16 v[40:43], v[248:251], v[184:187], v[40:43]
    v_mfma_f32_16x16x32_bf16 v[44:47], v[252:255], v[184:187], v[44:47]
    v_mfma_f32_16x16x32_bf16 v[48:51], v[248:251], v[188:191], v[48:51]
    v_mfma_f32_16x16x32_bf16 v[52:55], v[252:255], v[188:191], v[52:55]
    v_mfma_f32_16x16x32_bf16 v[56:59], v[248:251], v[192:195], v[56:59]
    v_mfma_f32_16x16x32_bf16 v[60:63], v[252:255], v[192:195], v[60:63]
    s_add_u32 s41, s47, 55296
    buffer_load_dwordx4 v[128:131], v7, s[8:11], s41 offen
    buffer_load_dwordx4 v[132:135], v7, s[8:11], s41 offen offset:1024
    s_cmp_lt_u32 s24, 4
    s_cbranch_scc1 GP_28
    s_setprio 0
GP_28:
    ds_read_b128 v[184:187], v1 offset:1472
    ds_read_b128 v[188:191], v3 offset:1472
    s_mov_b64 exec, s[48:49]
    ds_read_b128 v[192:195], v5 offset:1472
    s_mov_b64 exec, -1
    s_waitcnt vmcnt(16) lgkmcnt(9)
    v_mfma_f32_16x16x32_bf16 v[40:43], v[64:67], v[196:199], v[40:43]
    v_mfma_f32_16x16x32_bf16 v[44:47], v[68:71], v[196:199], v[44:47]
    v_mfma_f32_16x16x32_bf16 v[48:51], v[64:67], v[200:203], v[48:51]
    v_mfma_f32_16x16x32_bf16 v[52:55], v[68:71], v[200:203], v[52:55]
    v_mfma_f32_16x16x32_bf16 v[56:59], v[64:67], v[204:207], v[56:59]
    v_mfma_f32_16x16x32_bf16 v[60:63], v[68:71], v[204:207], v[60:63]
    ds_read_b128 v[196:199], v1 offset:1408
    ds_read_b128 v[200:203], v3 offset:1408
    s_mov_b64 exec, s[48:49]
    ds_read_b128 v[204:207], v5 offset:1408
    s_mov_b64 exec, -1
    s_waitcnt vmcnt(14) lgkmcnt(9)
    v_mfma_f32_16x16x32_bf16 v[40:43], v[72:75], v[160:163], v[40:43]
    v_mfma_f32_16x16x32_bf16 v[44:47], v[76:79], v[160:163], v[44:47]
    v_mfma_f32_16x16x32_bf16 v[48:51], v[72:75], v[164:167], v[48:51]
    v_mfma_f32_16x16x32_bf16 v[52:55], v[76:79], v[164:167], v[52:55]
    v_mfma_f32_16x16x32_bf16 v[56:59], v[72:75], v[168:171], v[56:59]
    v_mfma_f32_16x16x32_bf16 v[60:63], v[76:79], v[168:171], v[60:63]
    s_add_u32 s41, s47, 57344
    buffer_load_dwordx4 v[136:139], v7, s[8:11], s41 offen
    buffer_load_dwordx4 v[140:143], v7, s[8:11], s41 offen offset:1024
    ds_read_b128 v[160:163], v2 offset:1600
    ds_read_b128 v[164:167], v4 offset:1600
    s_mov_b64 exec, s[48:49]
    ds_read_b128 v[168:171], v6 offset:1600
    s_mov_b64 exec, -1
    s_waitcnt vmcnt(14) lgkmcnt(9)
    v_mfma_f32_16x16x32_bf16 v[40:43], v[80:83], v[172:175], v[40:43]
    v_mfma_f32_16x16x32_bf16 v[44:47], v[84:87], v[172:175], v[44:47]
    v_mfma_f32_16x16x32_bf16 v[48:51], v[80:83], v[176:179], v[48:51]
    v_mfma_f32_16x16x32_bf16 v[52:55], v[84:87], v[176:179], v[52:55]
    v_mfma_f32_16x16x32_bf16 v[56:59], v[80:83], v[180:183], v[56:59]
    v_mfma_f32_16x16x32_bf16 v[60:63], v[84:87], v[180:183], v[60:63]
    s_add_u32 s41, s47, 59392
    buffer_load_dwordx4 v[144:147], v7, s[8:11], s41 offen
    buffer_load_dwordx4 v[148:151], v7, s[8:11], s41 offen offset:1024
    ds_read_b128 v[172:175], v2 offset:1536
    ds_read_b128 v[176:179], v4 offset:1536
    s_mov_b64 exec, s[48:49]
    ds_read_b128 v[180:183], v6 offset:1536
    s_mov_b64 exec, -1
    s_waitcnt vmcnt(14) lgkmcnt(9)
    v_mfma_f32_16x16x32_bf16 v[40:43], v[88:91], v[184:187], v[40:43]
    v_mfma_f32_16x16x32_bf16 v[44:47], v[92:95], v[184:187], v[44:47]
    v_mfma_f32_16x16x32_bf16 v[48:51], v[88:91], v[188:191], v[48:51]
    v_mfma_f32_16x16x32_bf16 v[52:55], v[92:95], v[188:191], v[52:55]
    v_mfma_f32_16x16x32_bf16 v[56:59], v[88:91], v[192:195], v[56:59]
    v_mfma_f32_16x16x32_bf16 v[60:63], v[92:95], v[192:195], v[60:63]
    s_add_u32 s41, s47, 61440
    buffer_load_dwordx4 v[152:155], v7, s[8:11], s41 offen
    buffer_load_dwordx4 v[156:159], v7, s[8:11], s41 offen offset:1024
    ds_read_b128 v[184:187], v2 offset:1728
    ds_read_b128 v[188:191], v4 offset:1728
    s_mov_b64 exec, s[48:49]
    ds_read_b128 v[192:195], v6 offset:1728
    s_mov_b64 exec, -1
    s_waitcnt vmcnt(14) lgkmcnt(9)
    v_mfma_f32_16x16x32_bf16 v[40:43], v[96:99], v[196:199], v[40:43]
    v_mfma_f32_16x16x32_bf16 v[44:47], v[100:103], v[196:199], v[44:47]
    v_mfma_f32_16x16x32_bf16 v[48:51], v[96:99], v[200:203], v[48:51]
    v_mfma_f32_16x16x32_bf16 v[52:55], v[100:103], v[200:203], v[52:55]
    v_mfma_f32_16x16x32_bf16 v[56:59], v[96:99], v[204:207], v[56:59]
    v_mfma_f32_16x16x32_bf16 v[60:63], v[100:103], v[204:207], v[60:63]
    ds_read_b128 v[196:199], v2 offset:1664
    ds_read_b128 v[200:203], v4 offset:1664
    s_mov_b64 exec, s[48:49]
    ds_read_b128 v[204:207], v6 offset:1664
    s_mov_b64 exec, -1
    s_waitcnt vmcnt(12) lgkmcnt(9)
    v_mfma_f32_16x16x32_bf16 v[40:43], v[104:107], v[160:163], v[40:43]
    v_mfma_f32_16x16x32_bf16 v[44:47], v[108:111], v[160:163], v[44:47]
    v_mfma_f32_16x16x32_bf16 v[48:51], v[104:107], v[164:167], v[48:51]
    v_mfma_f32_16x16x32_bf16 v[52:55], v[108:111], v[164:167], v[52:55]
    v_mfma_f32_16x16x32_bf16 v[56:59], v[104:107], v[168:171], v[56:59]
    v_mfma_f32_16x16x32_bf16 v[60:63], v[108:111], v[168:171], v[60:63]
    s_add_u32 s41, s47, 63488
    buffer_load_dwordx4 v[224:227], v7, s[8:11], s41 offen
    buffer_load_dwordx4 v[228:231], v7, s[8:11], s41 offen offset:1024
    ds_read_b128 v[160:163], v2 offset:1856
    ds_read_b128 v[164:167], v4 offset:1856
    s_mov_b64 exec, s[48:49]
    ds_read_b128 v[168:171], v6 offset:1856
    s_mov_b64 exec, -1
    s_waitcnt vmcnt(12) lgkmcnt(9)
    v_mfma_f32_16x16x32_bf16 v[40:43], v[112:115], v[172:175], v[40:43]
    v_mfma_f32_16x16x32_bf16 v[44:47], v[116:119], v[172:175], v[44:47]
    v_mfma_f32_16x16x32_bf16 v[48:51], v[112:115], v[176:179], v[48:51]
    v_mfma_f32_16x16x32_bf16 v[52:55], v[116:119], v[176:179], v[52:55]
    v_mfma_f32_16x16x32_bf16 v[56:59], v[112:115], v[180:183], v[56:59]
    v_mfma_f32_16x16x32_bf16 v[60:63], v[116:119], v[180:183], v[60:63]
    ds_read_b128 v[172:175], v2 offset:1792
    ds_read_b128 v[176:179], v4 offset:1792
    s_mov_b64 exec, s[48:49]
    ds_read_b128 v[180:183], v6 offset:1792
    s_mov_b64 exec, -1
    s_waitcnt vmcnt(10) lgkmcnt(9)
    v_mfma_f32_16x16x32_bf16 v[40:43], v[120:123], v[184:187], v[40:43]
    v_mfma_f32_16x16x32_bf16 v[44:47], v[124:127], v[184:187], v[44:47]
    v_mfma_f32_16x16x32_bf16 v[48:51], v[120:123], v[188:191], v[48:51]
    v_mfma_f32_16x16x32_bf16 v[52:55], v[124:127], v[188:191], v[52:55]
    v_mfma_f32_16x16x32_bf16 v[56:59], v[120:123], v[192:195], v[56:59]
    v_mfma_f32_16x16x32_bf16 v[60:63], v[124:127], v[192:195], v[60:63]
    ds_read_b128 v[184:187], v2 offset:1984
    ds_read_b128 v[188:191], v4 offset:1984
    s_mov_b64 exec, s[48:49]
    ds_read_b128 v[192:195], v6 offset:1984
    s_mov_b64 exec, -1
    s_waitcnt vmcnt(8) lgkmcnt(9)
    v_mfma_f32_16x16x32_bf16 v[40:43], v[128:131], v[196:199], v[40:43]
    v_mfma_f32_16x16x32_bf16 v[44:47], v[132:135], v[196:199], v[44:47]
    v_mfma_f32_16x16x32_bf16 v[48:51], v[128:131], v[200:203], v[48:51]
    v_mfma_f32_16x16x32_bf16 v[52:55], v[132:135], v[200:203], v[52:55]
    v_mfma_f32_16x16x32_bf16 v[56:59], v[128:131], v[204:207], v[56:59]
    v_mfma_f32_16x16x32_bf16 v[60:63], v[132:135], v[204:207], v[60:63]
    ds_read_b128 v[196:199], v2 offset:1920
    ds_read_b128 v[200:203], v4 offset:1920
    s_mov_b64 exec, s[48:49]
    ds_read_b128 v[204:207], v6 offset:1920
    s_mov_b64 exec, -1
    s_waitcnt vmcnt(6) lgkmcnt(9)
    v_mfma_f32_16x16x32_bf16 v[40:43], v[136:139], v[160:163], v[40:43]
    v_mfma_f32_16x16x32_bf16 v[44:47], v[140:143], v[160:163], v[44:47]
    v_mfma_f32_16x16x32_bf16 v[48:51], v[136:139], v[164:167], v[48:51]
    v_mfma_f32_16x16x32_bf16 v[52:55], v[140:143], v[164:167], v[52:55]
    v_mfma_f32_16x16x32_bf16 v[56:59], v[136:139], v[168:171], v[56:59]
    v_mfma_f32_16x16x32_bf16 v[60:63], v[140:143], v[168:171], v[60:63]
    s_waitcnt vmcnt(4) lgkmcnt(6)
    v_mfma_f32_16x16x32_bf16 v[40:43], v[144:147], v[172:175], v[40:43]
    v_mfma_f32_16x16x32_bf16 v[44:47], v[148:151], v[172:175], v[44:47]
    v_mfma_f32_16x16x32_bf16 v[48:51], v[144:147], v[176:179], v[48:51]
    v_mfma_f32_16x16x32_bf16 v[52:55], v[148:151], v[176:179], v[52:55]
    v_mfma_f32_16x16x32_bf16 v[56:59], v[144:147], v[180:183], v[56:59]
    v_mfma_f32_16x16x32_bf16 v[60:63], v[148:151], v[180:183], v[60:63]
    s_waitcnt vmcnt(2) lgkmcnt(3)
    v_mfma_f32_16x16x32_bf16 v[40:43], v[152:155], v[184:187], v[40:43]
    v_mfma_f32_16x16x32_bf16 v[44:47], v[156:159], v[184:187], v[44:47]
    v_mfma_f32_16x16x32_bf16 v[48:51], v[152:155], v[188:191], v[48:51]
    v_mfma_f32_16x16x32_bf16 v[52:55], v[156:159], v[188:191], v[52:55]
    v_mfma_f32_16x16x32_bf16 v[56:59], v[152:155], v[192:195], v[56:59]
    v_mfma_f32_16x16x32_bf16 v[60:63], v[156:159], v[192:195], v[60:63]
    s_waitcnt vmcnt(0) lgkmcnt(0)
    v_mfma_f32_16x16x32_bf16 v[40:43], v[224:227], v[196:199], v[40:43]
    v_mfma_f32_16x16x32_bf16 v[44:47], v[228:231], v[196:199], v[44:47]
    v_mfma_f32_16x16x32_bf16 v[48:51], v[224:227], v[200:203], v[48:51]
    v_mfma_f32_16x16x32_bf16 v[52:55], v[228:231], v[200:203], v[52:55]
    v_mfma_f32_16x16x32_bf16 v[56:59], v[224:227], v[204:207], v[56:59]
    v_mfma_f32_16x16x32_bf16 v[60:63], v[228:231], v[204:207], v[60:63]
    s_nop 7
    v_cvt_pk_bf16_f32 v12, v40, v41
    v_cvt_pk_bf16_f32 v13, v42, v43
    v_cvt_pk_bf16_f32 v14, v44, v45
    v_cvt_pk_bf16_f32 v15, v46, v47
    buffer_store_dwordx4 v[12:15], v8, s[12:15], 0 offen
    v_cvt_pk_bf16_f32 v16, v48, v49
    v_cvt_pk_bf16_f32 v17, v50, v51
    v_cvt_pk_bf16_f32 v18, v52, v53
    v_cvt_pk_bf16_f32 v19, v54, v55
    buffer_store_dwordx4 v[16:19], v9, s[12:15], 0 offen
    v_cvt_pk_bf16_f32 v20, v56, v57
    v_cvt_pk_bf16_f32 v21, v58, v59
    v_cvt_pk_bf16_f32 v22, v60, v61
    v_cvt_pk_bf16_f32 v23, v62, v63
    buffer_store_dwordx4 v[20:23], v10, s[12:15], 0 offen
    s_endpgm
MAIN_SLOW:
    ds_read_b128 v[160:163], v39 offset:2304
    ds_read_b128 v[164:167], v39 offset:2368
    ds_read_b128 v[168:171], v39 offset:2432
    ds_read_b128 v[172:175], v39 offset:2496
    ds_read_b128 v[176:179], v39 offset:2560
    ds_read_b128 v[180:183], v39 offset:2624
    ds_read_b128 v[184:187], v39 offset:2688
    ds_read_b128 v[188:191], v39 offset:2752
    ds_read_b128 v[128:131], v39 offset:0
    ds_read_b128 v[132:135], v39 offset:64
    ds_read_b128 v[136:139], v39 offset:128
    ds_read_b128 v[140:143], v39 offset:192
    ds_read_b128 v[144:147], v39 offset:256
    ds_read_b128 v[148:151], v39 offset:320
    ds_read_b128 v[152:155], v39 offset:384
    ds_read_b128 v[156:159], v39 offset:448
    s_waitcnt lgkmcnt(0)
    s_barrier
    s_waitcnt vmcnt(0)
    ds_read_b128 v[64:67], v2 offset:8704
    ds_read_b128 v[68:71], v2 offset:8768
    ds_read_b128 v[72:75], v2 offset:8832
    ds_read_b128 v[76:79], v2 offset:8896
    ds_read_b128 v[80:83], v2 offset:8960
    ds_read_b128 v[84:87], v2 offset:9024
    ds_read_b128 v[88:91], v2 offset:9088
    ds_read_b128 v[92:95], v2 offset:9152
    v_lshlrev_b32 v43, 2, v36
    v_and_b32 v44, 3, v36
    v_add_u32 v44, 16, v44
    v_lshlrev_b32 v44, 2, v44
    s_waitcnt lgkmcnt(7)
    v_mfma_f32_16x16x32_bf16 v[28:31], v[64:67], v[160:163], 0
    s_waitcnt lgkmcnt(6)
    v_mfma_f32_16x16x32_bf16 v[28:31], v[68:71], v[164:167], v[28:31]
    s_waitcnt lgkmcnt(5)
    v_mfma_f32_16x16x32_bf16 v[28:31], v[72:75], v[168:171], v[28:31]
    s_waitcnt lgkmcnt(4)
    v_mfma_f32_16x16x32_bf16 v[28:31], v[76:79], v[172:175], v[28:31]
    s_waitcnt lgkmcnt(3)
    v_mfma_f32_16x16x32_bf16 v[28:31], v[80:83], v[176:179], v[28:31]
    s_waitcnt lgkmcnt(2)
    v_mfma_f32_16x16x32_bf16 v[28:31], v[84:87], v[180:183], v[28:31]
    s_waitcnt lgkmcnt(1)
    v_mfma_f32_16x16x32_bf16 v[28:31], v[88:91], v[184:187], v[28:31]
    s_waitcnt lgkmcnt(0)
    v_mfma_f32_16x16x32_bf16 v[28:31], v[92:95], v[188:191], v[28:31]
    s_nop 7
    v_cndmask_b32 v41, v28, v29, s[70:71]
    v_cndmask_b32 v41, v41, v30, s[72:73]
    v_cndmask_b32 v41, v41, v31, s[74:75]
    ds_bpermute_b32 v8, v44, v28
    ds_bpermute_b32 v41, v43, v41
    s_waitcnt lgkmcnt(0)
    v_mov_b32 v9, v8
    v_mov_b32 v10, v8
    v_mov_b32 v11, v8
    s_add_u32 s41, s47, 0
    buffer_load_dwordx4 v[232:235], v45, s[8:11], s41 offen
    buffer_load_dwordx4 v[236:239], v45, s[8:11], s41 offen offset:1024
    s_add_u32 s41, s47, 2048
    buffer_load_dwordx4 v[240:243], v45, s[8:11], s41 offen
    buffer_load_dwordx4 v[244:247], v45, s[8:11], s41 offen offset:1024
    s_waitcnt vmcnt(0)
    v_mov_b32 v160, 0
    v_mov_b32 v161, 0
    v_mov_b32 v162, 0
    v_mov_b32 v163, 0
    v_mov_b32 v164, 0
    v_mov_b32 v165, 0
    v_mov_b32 v166, 0
    v_mov_b32 v167, 0
    v_mov_b32 v168, 0
    v_mov_b32 v169, 0
    v_mov_b32 v170, 0
    v_mov_b32 v171, 0
    v_mov_b32 v172, 0
    v_mov_b32 v173, 0
    v_mov_b32 v174, 0
    v_mov_b32 v175, 0
    v_mov_b32 v176, 0
    v_mov_b32 v177, 0
    v_mov_b32 v178, 0
    v_mov_b32 v179, 0
    v_mov_b32 v180, 0
    v_mov_b32 v181, 0
    v_mov_b32 v182, 0
    v_mov_b32 v183, 0
    v_mov_b32 v184, 0
    v_mov_b32 v185, 0
    v_mov_b32 v186, 0
    v_mov_b32 v187, 0
    v_mov_b32 v188, 0
    v_mov_b32 v189, 0
    v_mov_b32 v190, 0
    v_mov_b32 v191, 0
    v_mov_b32 v192, 0
    v_mov_b32 v193, 0
    v_mov_b32 v194, 0
    v_mov_b32 v195, 0
    v_mov_b32 v196, 0
    v_mov_b32 v197, 0
    v_mov_b32 v198, 0
    v_mov_b32 v199, 0
    v_mov_b32 v200, 0
    v_mov_b32 v201, 0
    v_mov_b32 v202, 0
    v_mov_b32 v203, 0
    v_mov_b32 v204, 0
    v_mov_b32 v205, 0
    v_mov_b32 v206, 0
    v_mov_b32 v207, 0
    v_mov_b32 v208, 0
    v_mov_b32 v209, 0
    v_mov_b32 v210, 0
    v_mov_b32 v211, 0
    v_mov_b32 v212, 0
    v_mov_b32 v213, 0
    v_mov_b32 v214, 0
    v_mov_b32 v215, 0
    v_mov_b32 v216, 0
    v_mov_b32 v217, 0
    v_mov_b32 v218, 0
    v_mov_b32 v219, 0
    v_mov_b32 v220, 0
    v_mov_b32 v221, 0
    v_mov_b32 v222, 0
    v_mov_b32 v223, 0
    v_mov_b32 v32, 0
    v_mov_b32 v33, 0
    v_mov_b32 v34, 0
    v_mov_b32 v35, 0
    s_mul_i32 s67, s2, 40
    s_mov_b32 s62, 0
    s_mov_b32 s26, 1
    s_mov_b32 s25, 1
SLOW_GROUP:
    s_add_u32 s65, s24, 32
    s_add_u32 s66, s65, 1
    s_cmp_eq_u32 s62, 0
    s_cbranch_scc1 SLOW_RANGE
    s_lshl_b32 s65, s24, 2
    s_add_u32 s66, s65, 4
SLOW_RANGE:
    s_mov_b32 s63, 0
SLOW_REFILL:
    v_mbcnt_lo_u32_b32 v42, -1, 0
    v_mbcnt_hi_u32_b32 v42, -1, v42
    v_lshlrev_b32 v42, 2, v42
    v_mov_b32 v43, 0x7ffffe3f
    v_add_u32 v44, s44, v42
    ds_write_b32 v44, v43
    ds_write_b32 v44, v43 offset:256
    s_mov_b32 s64, 0
SLOW_SCAN:
    s_cmp_ge_u32 s63, 640000
    s_cbranch_scc1 SLOW_FLUSH
    s_cmp_gt_u32 s64, 64
    s_cbranch_scc1 SLOW_FLUSH
    buffer_load_dword v43, v42, s[20:23], s63 offen
    buffer_load_dword v44, v42, s[16:19], s63 offen
    s_add_u32 s63, s63, 256
    s_waitcnt vmcnt(0)
    v_subrev_u32 v43, s67, v43
    v_cmp_le_u32 s[68:69], s65, v43
    v_cmp_gt_u32 vcc, s66, v43
    s_and_b64 vcc, vcc, s[68:69]
    v_lshl_or_b32 v44, v44, 9, v43
    s_nop 0
    v_mbcnt_lo_u32_b32 v0, vcc_lo, 0
    v_mbcnt_hi_u32_b32 v0, vcc_hi, v0
    v_add_u32 v0, s64, v0
    v_lshlrev_b32 v0, 2, v0
    v_add_u32 v0, s44, v0
    s_bcnt1_i32_b64 s41, vcc
    s_add_u32 s64, s64, s41
    s_and_saveexec_b64 s[48:49], vcc
    ds_write_b32 v0, v44
    s_mov_b64 exec, s[48:49]
    s_branch SLOW_SCAN
SLOW_FLUSH:
    s_add_u32 s27, s64, 15
    s_lshr_b32 s27, s27, 4
    s_mov_b32 s28, 0
    s_mov_b32 s29, s44
    s_waitcnt lgkmcnt(0)
SLOW_UNIT:
    s_cmp_ge_u32 s28, s27
    s_cbranch_scc1 SLOW_UNITS_DONE
    v_add_u32 v42, s29, v6
    ds_read2_b32 v[20:21], v42 offset0:0 offset1:2
    ds_read2_b32 v[22:23], v42 offset0:4 offset1:6
    ds_read2_b32 v[24:25], v42 offset0:8 offset1:10
    ds_read2_b32 v[26:27], v42 offset0:12 offset1:14
    s_waitcnt lgkmcnt(0)
    s_mov_b32 m0, s30
    v_and_or_b32 v20, v20, s40, v1
    buffer_load_dwordx4 v20, s[4:7], 0 offen lds
    s_add_u32 m0, s30, 1088
    v_and_or_b32 v21, v21, s40, v1
    buffer_load_dwordx4 v21, s[4:7], 0 offen lds
    s_add_u32 m0, s30, 2176
    v_and_or_b32 v22, v22, s40, v1
    buffer_load_dwordx4 v22, s[4:7], 0 offen lds
    s_add_u32 m0, s30, 3264
    v_and_or_b32 v23, v23, s40, v1
    buffer_load_dwordx4 v23, s[4:7], 0 offen lds
    s_add_u32 m0, s30, 4352
    v_and_or_b32 v24, v24, s40, v1
    buffer_load_dwordx4 v24, s[4:7], 0 offen lds
    s_add_u32 m0, s30, 5440
    v_and_or_b32 v25, v25, s40, v1
    buffer_load_dwordx4 v25, s[4:7], 0 offen lds
    s_add_u32 m0, s30, 6528
    v_and_or_b32 v26, v26, s40, v1
    buffer_load_dwordx4 v26, s[4:7], 0 offen lds
    s_add_u32 m0, s30, 7616
    v_and_or_b32 v27, v27, s40, v1
    buffer_load_dwordx4 v27, s[4:7], 0 offen lds
    s_mov_b32 s46, s29
    s_waitcnt vmcnt(0)
    v_add_u32 v0, s29, v5
    ds_read_b128 v[16:19], v0
    ds_read_b128 v[48:51], v2 offset:0
    ds_read_b128 v[52:55], v2 offset:64
    ds_read_b128 v[56:59], v2 offset:128
    ds_read_b128 v[60:63], v2 offset:192
    v_add_u32 v42, s46, v6
    s_waitcnt lgkmcnt(3)
    v_mfma_f32_16x16x32_bf16 v[28:31], v[48:51], v[128:131], v[8:11]
    ds_read_b128 v[48:51], v2 offset:256
    ds_read_b64_tr_b16 v[64:65], v3 offset:0
    ds_read_b64_tr_b16 v[68:69], v4 offset:32
    ds_read_b64_tr_b16 v[72:73], v3 offset:64
    ds_read_b64_tr_b16 v[76:77], v4 offset:96
    s_waitcnt lgkmcnt(7)
    v_mfma_f32_16x16x32_bf16 v[28:31], v[52:55], v[132:135], v[28:31]
    ds_read_b128 v[52:55], v2 offset:320
    ds_read_b64_tr_b16 v[80:81], v3 offset:128
    ds_read_b64_tr_b16 v[84:85], v4 offset:160
    ds_read_b64_tr_b16 v[88:89], v3 offset:192
    ds_read_b64_tr_b16 v[92:93], v4 offset:224
    s_waitcnt lgkmcnt(11)
    v_mfma_f32_16x16x32_bf16 v[28:31], v[56:59], v[136:139], v[28:31]
    ds_read_b128 v[56:59], v2 offset:384
    ds_read_b64_tr_b16 v[96:97], v3 offset:256
    ds_read_b64_tr_b16 v[100:101], v4 offset:288
    ds_read_b64_tr_b16 v[104:105], v3 offset:320
    ds_read_b64_tr_b16 v[108:109], v4 offset:352
    s_waitcnt lgkmcnt(14)
    v_mfma_f32_16x16x32_bf16 v[28:31], v[60:63], v[140:143], v[28:31]
    ds_read_b128 v[60:63], v2 offset:448
    ds_read_b64_tr_b16 v[112:113], v3 offset:384
    ds_read_b64_tr_b16 v[116:117], v4 offset:416
    ds_read_b64_tr_b16 v[120:121], v3 offset:448
    ds_read_b64_tr_b16 v[124:125], v4 offset:480
    ds_read2_b32 v[20:21], v42 offset0:0 offset1:2
    ds_read2_b32 v[22:23], v42 offset0:4 offset1:6
    ds_read2_b32 v[24:25], v42 offset0:8 offset1:10
    ds_read2_b32 v[26:27], v42 offset0:12 offset1:14
    s_waitcnt lgkmcnt(14)
    v_mfma_f32_16x16x32_bf16 v[28:31], v[48:51], v[144:147], v[28:31]
    s_waitcnt lgkmcnt(14)
    v_mfma_f32_16x16x32_bf16 v[28:31], v[52:55], v[148:151], v[28:31]
    s_waitcnt lgkmcnt(13)
    v_mfma_f32_16x16x32_bf16 v[28:31], v[56:59], v[152:155], v[28:31]
    s_waitcnt lgkmcnt(0)
    v_mfma_f32_16x16x32_bf16 v[28:31], v[60:63], v[156:159], v[28:31]
    v_cmp_eq_u32_sdwa s[32:33], v16, v7 src0_sel:BYTE_0 src1_sel:DWORD
    v_cmp_eq_u32_sdwa s[34:35], v17, v7 src0_sel:BYTE_0 src1_sel:DWORD
    v_cmp_eq_u32_sdwa s[36:37], v18, v7 src0_sel:BYTE_0 src1_sel:DWORD
    v_cmp_eq_u32_sdwa s[38:39], v19, v7 src0_sel:BYTE_0 src1_sel:DWORD
    s_nop 3
    v_pk_mul_f32 v[36:37], v[28:29], s[50:51] op_sel_hi:[1,0]
    v_pk_mul_f32 v[38:39], v[30:31], s[50:51] op_sel_hi:[1,0]
    v_max_f32 v36, v36, v28
    v_max_f32 v37, v37, v29
    v_max_f32 v38, v38, v30
    v_max_f32 v39, v39, v31
    v_exp_f32 v36, v36
    v_exp_f32 v37, v37
    v_exp_f32 v38, v38
    v_exp_f32 v39, v39
    v_cndmask_b32 v36, 0, v36, s[32:33]
    v_cndmask_b32 v37, 0, v37, s[34:35]
    v_cndmask_b32 v38, 0, v38, s[36:37]
    v_cndmask_b32 v39, 0, v39, s[38:39]
    v_cvt_pk_bf16_f32 v12, v36, v37
    v_cvt_pk_bf16_f32 v13, v38, v39
    s_nop 1
    v_mfma_f32_16x16x16_bf16 v[32:35], v[224:225], v[12:13], v[32:35]
    v_mfma_f32_16x16x16_bf16 v[160:163], v[64:65], v[12:13], v[160:163]
    v_mfma_f32_16x16x16_bf16 v[164:167], v[68:69], v[12:13], v[164:167]
    v_mfma_f32_16x16x16_bf16 v[168:171], v[72:73], v[12:13], v[168:171]
    v_mfma_f32_16x16x16_bf16 v[172:175], v[76:77], v[12:13], v[172:175]
    v_mfma_f32_16x16x16_bf16 v[176:179], v[80:81], v[12:13], v[176:179]
    v_mfma_f32_16x16x16_bf16 v[180:183], v[84:85], v[12:13], v[180:183]
    v_mfma_f32_16x16x16_bf16 v[184:187], v[88:89], v[12:13], v[184:187]
    v_mfma_f32_16x16x16_bf16 v[188:191], v[92:93], v[12:13], v[188:191]
    v_mfma_f32_16x16x16_bf16 v[192:195], v[96:97], v[12:13], v[192:195]
    v_mfma_f32_16x16x16_bf16 v[196:199], v[100:101], v[12:13], v[196:199]
    v_mfma_f32_16x16x16_bf16 v[200:203], v[104:105], v[12:13], v[200:203]
    v_mfma_f32_16x16x16_bf16 v[204:207], v[108:109], v[12:13], v[204:207]
    v_mfma_f32_16x16x16_bf16 v[208:211], v[112:113], v[12:13], v[208:211]
    v_mfma_f32_16x16x16_bf16 v[212:215], v[116:117], v[12:13], v[212:215]
    v_mfma_f32_16x16x16_bf16 v[216:219], v[120:121], v[12:13], v[216:219]
    v_mfma_f32_16x16x16_bf16 v[220:223], v[124:125], v[12:13], v[220:223]
    s_add_u32 s28, s28, 1
    s_add_u32 s29, s29, 64
    s_branch SLOW_UNIT
SLOW_UNITS_DONE:
    s_cmp_lt_u32 s63, 640000
    s_cbranch_scc1 SLOW_REFILL
    s_cmp_eq_u32 s62, 1
    s_cbranch_scc1 MAIN_DONE
    s_nop 7
    s_cmp_lg_u32 s26, 0
    s_cbranch_scc1 FB_29
    v_mov_b32 v160, 0
    v_mov_b32 v161, 0
    v_mov_b32 v162, 0
    v_mov_b32 v163, 0
    v_mov_b32 v164, 0
    v_mov_b32 v165, 0
    v_mov_b32 v166, 0
    v_mov_b32 v167, 0
    v_mov_b32 v168, 0
    v_mov_b32 v169, 0
    v_mov_b32 v170, 0
    v_mov_b32 v171, 0
    v_mov_b32 v172, 0
    v_mov_b32 v173, 0
    v_mov_b32 v174, 0
    v_mov_b32 v175, 0
    v_mov_b32 v176, 0
    v_mov_b32 v177, 0
    v_mov_b32 v178, 0
    v_mov_b32 v179, 0
    v_mov_b32 v180, 0
    v_mov_b32 v181, 0
    v_mov_b32 v182, 0
    v_mov_b32 v183, 0
    v_mov_b32 v184, 0
    v_mov_b32 v185, 0
    v_mov_b32 v186, 0
    v_mov_b32 v187, 0
    v_mov_b32 v188, 0
    v_mov_b32 v189, 0
    v_mov_b32 v190, 0
    v_mov_b32 v191, 0
    v_mov_b32 v192, 0
    v_mov_b32 v193, 0
    v_mov_b32 v194, 0
    v_mov_b32 v195, 0
    v_mov_b32 v196, 0
    v_mov_b32 v197, 0
    v_mov_b32 v198, 0
    v_mov_b32 v199, 0
    v_mov_b32 v200, 0
    v_mov_b32 v201, 0
    v_mov_b32 v202, 0
    v_mov_b32 v203, 0
    v_mov_b32 v204, 0
    v_mov_b32 v205, 0
    v_mov_b32 v206, 0
    v_mov_b32 v207, 0
    v_mov_b32 v208, 0
    v_mov_b32 v209, 0
    v_mov_b32 v210, 0
    v_mov_b32 v211, 0
    v_mov_b32 v212, 0
    v_mov_b32 v213, 0
    v_mov_b32 v214, 0
    v_mov_b32 v215, 0
    v_mov_b32 v216, 0
    v_mov_b32 v217, 0
    v_mov_b32 v218, 0
    v_mov_b32 v219, 0
    v_mov_b32 v220, 0
    v_mov_b32 v221, 0
    v_mov_b32 v222, 0
    v_mov_b32 v223, 0
    v_mov_b32 v32, 0
    v_mov_b32 v33, 0
    v_mov_b32 v34, 0
    v_mov_b32 v35, 0
FB_29:
    v_add_f32 v36, 0x3089705f, v32
    v_rcp_f32 v36, v36
    v_cndmask_b32 v160, v160, v176, s[70:71]
    v_mul_f32 v36, 0x3e800000, v36
    v_cndmask_b32 v161, v161, v177, s[70:71]
    v_cndmask_b32 v162, v162, v178, s[70:71]
    v_cndmask_b32 v163, v163, v179, s[70:71]
    v_cndmask_b32 v164, v164, v180, s[70:71]
    v_cndmask_b32 v165, v165, v181, s[70:71]
    v_cndmask_b32 v166, v166, v182, s[70:71]
    v_cndmask_b32 v167, v167, v183, s[70:71]
    v_cndmask_b32 v168, v168, v184, s[70:71]
    v_cndmask_b32 v169, v169, v185, s[70:71]
    v_cndmask_b32 v170, v170, v186, s[70:71]
    v_cndmask_b32 v171, v171, v187, s[70:71]
    v_cndmask_b32 v172, v172, v188, s[70:71]
    v_cndmask_b32 v173, v173, v189, s[70:71]
    v_cndmask_b32 v174, v174, v190, s[70:71]
    v_cndmask_b32 v175, v175, v191, s[70:71]
    v_cndmask_b32 v160, v160, v192, s[72:73]
    v_cndmask_b32 v161, v161, v193, s[72:73]
    v_cndmask_b32 v162, v162, v194, s[72:73]
    v_cndmask_b32 v163, v163, v195, s[72:73]
    v_cndmask_b32 v164, v164, v196, s[72:73]
    v_cndmask_b32 v165, v165, v197, s[72:73]
    v_cndmask_b32 v166, v166, v198, s[72:73]
    v_cndmask_b32 v167, v167, v199, s[72:73]
    v_cndmask_b32 v168, v168, v200, s[72:73]
    v_cndmask_b32 v169, v169, v201, s[72:73]
    v_cndmask_b32 v170, v170, v202, s[72:73]
    v_cndmask_b32 v171, v171, v203, s[72:73]
    v_cndmask_b32 v172, v172, v204, s[72:73]
    v_cndmask_b32 v173, v173, v205, s[72:73]
    v_cndmask_b32 v174, v174, v206, s[72:73]
    v_cndmask_b32 v175, v175, v207, s[72:73]
    v_cndmask_b32 v160, v160, v208, s[74:75]
    v_cndmask_b32 v161, v161, v209, s[74:75]
    v_cndmask_b32 v162, v162, v210, s[74:75]
    v_cndmask_b32 v163, v163, v211, s[74:75]
    v_cndmask_b32 v164, v164, v212, s[74:75]
    v_cndmask_b32 v165, v165, v213, s[74:75]
    v_cndmask_b32 v166, v166, v214, s[74:75]
    v_cndmask_b32 v167, v167, v215, s[74:75]
    v_cndmask_b32 v168, v168, v216, s[74:75]
    v_cndmask_b32 v169, v169, v217, s[74:75]
    v_cndmask_b32 v170, v170, v218, s[74:75]
    v_cndmask_b32 v171, v171, v219, s[74:75]
    v_cndmask_b32 v172, v172, v220, s[74:75]
    v_cndmask_b32 v173, v173, v221, s[74:75]
    v_cndmask_b32 v174, v174, v222, s[74:75]
    v_cndmask_b32 v175, v175, v223, s[74:75]
    v_pk_mul_f32 v[160:161], v[160:161], v[36:37] op_sel_hi:[1,0]
    v_pk_mul_f32 v[162:163], v[162:163], v[36:37] op_sel_hi:[1,0]
    v_pk_mul_f32 v[164:165], v[164:165], v[36:37] op_sel_hi:[1,0]
    v_pk_mul_f32 v[166:167], v[166:167], v[36:37] op_sel_hi:[1,0]
    v_pk_mul_f32 v[168:169], v[168:169], v[36:37] op_sel_hi:[1,0]
    v_pk_mul_f32 v[170:171], v[170:171], v[36:37] op_sel_hi:[1,0]
    v_pk_mul_f32 v[172:173], v[172:173], v[36:37] op_sel_hi:[1,0]
    v_pk_mul_f32 v[174:175], v[174:175], v[36:37] op_sel_hi:[1,0]
    v_cvt_pk_bf16_f32 v64, v160, v161
    v_cvt_pk_bf16_f32 v65, v162, v163
    v_cvt_pk_bf16_f32 v66, v164, v165
    v_cvt_pk_bf16_f32 v67, v166, v167
    v_cvt_pk_bf16_f32 v68, v168, v169
    v_cvt_pk_bf16_f32 v69, v170, v171
    v_cvt_pk_bf16_f32 v70, v172, v173
    v_cvt_pk_bf16_f32 v71, v174, v175
    ds_write_b128 v46, v[64:67]
    ds_write_b128 v47, v[68:71] offset:64
    v_mov_b32 v7, v40
    v_mov_b32 v8, v41
    v_mov_b32 v9, v41
    v_mov_b32 v10, v41
    v_mov_b32 v11, v41
    v_mbcnt_lo_u32_b32 v44, -1, 0
    v_mbcnt_hi_u32_b32 v44, -1, v44
    v_and_b32 v38, 15, v44
    v_lshrrev_b32 v39, 4, v44
    s_and_b32 s41, s24, 1
    s_lshl_b32 s41, s41, 7
    s_add_u32 s41, s41, s45
    v_lshrrev_b32 v46, 2, v38
    v_mul_u32_u24 v46, 2080, v46
    v_add_u32 v46, s41, v46
    v_and_b32 v42, 3, v38
    v_lshl_add_u32 v46, v42, 9, v46
    v_and_b32 v43, 1, v42
    v_xor_b32 v43, v43, v39
    v_lshl_add_u32 v46, v43, 4, v46
    v_lshrrev_b32 v42, 1, v42
    v_lshlrev_b32 v42, 6, v42
    v_sub_u32 v47, v46, v42
    v_add_u32 v46, v46, v42
    s_mov_b32 s52, 1
    s_waitcnt lgkmcnt(0)
    v_mov_b32 v160, 0
    v_mov_b32 v161, 0
    v_mov_b32 v162, 0
    v_mov_b32 v163, 0
    v_mov_b32 v164, 0
    v_mov_b32 v165, 0
    v_mov_b32 v166, 0
    v_mov_b32 v167, 0
    v_mov_b32 v168, 0
    v_mov_b32 v169, 0
    v_mov_b32 v170, 0
    v_mov_b32 v171, 0
    v_mov_b32 v172, 0
    v_mov_b32 v173, 0
    v_mov_b32 v174, 0
    v_mov_b32 v175, 0
    v_mov_b32 v176, 0
    v_mov_b32 v177, 0
    v_mov_b32 v178, 0
    v_mov_b32 v179, 0
    v_mov_b32 v180, 0
    v_mov_b32 v181, 0
    v_mov_b32 v182, 0
    v_mov_b32 v183, 0
    v_mov_b32 v184, 0
    v_mov_b32 v185, 0
    v_mov_b32 v186, 0
    v_mov_b32 v187, 0
    v_mov_b32 v188, 0
    v_mov_b32 v189, 0
    v_mov_b32 v190, 0
    v_mov_b32 v191, 0
    v_mov_b32 v192, 0
    v_mov_b32 v193, 0
    v_mov_b32 v194, 0
    v_mov_b32 v195, 0
    v_mov_b32 v196, 0
    v_mov_b32 v197, 0
    v_mov_b32 v198, 0
    v_mov_b32 v199, 0
    v_mov_b32 v200, 0
    v_mov_b32 v201, 0
    v_mov_b32 v202, 0
    v_mov_b32 v203, 0
    v_mov_b32 v204, 0
    v_mov_b32 v205, 0
    v_mov_b32 v206, 0
    v_mov_b32 v207, 0
    v_mov_b32 v208, 0
    v_mov_b32 v209, 0
    v_mov_b32 v210, 0
    v_mov_b32 v211, 0
    v_mov_b32 v212, 0
    v_mov_b32 v213, 0
    v_mov_b32 v214, 0
    v_mov_b32 v215, 0
    v_mov_b32 v216, 0
    v_mov_b32 v217, 0
    v_mov_b32 v218, 0
    v_mov_b32 v219, 0
    v_mov_b32 v220, 0
    v_mov_b32 v221, 0
    v_mov_b32 v222, 0
    v_mov_b32 v223, 0
    v_mov_b32 v32, 0
    v_mov_b32 v33, 0
    v_mov_b32 v34, 0
    v_mov_b32 v35, 0
    s_mov_b32 s62, 1
    s_branch SLOW_GROUP
MAIN_END:
    s_endpgm
.section .rodata,"a"
.p2align 6
.amdhsa_kernel gat_prep_kernel
  .amdhsa_next_free_vgpr 80
  .amdhsa_next_free_sgpr 48
  .amdhsa_accum_offset 80
  .amdhsa_group_segment_fixed_size 0
  .amdhsa_kernarg_size 72
  .amdhsa_user_sgpr_count 2
  .amdhsa_user_sgpr_kernarg_segment_ptr 1
  .amdhsa_system_sgpr_workgroup_id_x 1
  .amdhsa_float_denorm_mode_32 3
.end_amdhsa_kernel

.p2align 6
.amdhsa_kernel gather_scatter__graph_attention_gat__graph_kernel
  .amdhsa_next_free_vgpr 256
  .amdhsa_next_free_sgpr 96
  .amdhsa_accum_offset 256
  .amdhsa_group_segment_fixed_size 0
  .amdhsa_kernarg_size 72
  .amdhsa_user_sgpr_count 2
  .amdhsa_user_sgpr_kernarg_segment_ptr 1
  .amdhsa_system_sgpr_workgroup_id_x 1
  .amdhsa_float_denorm_mode_32 3
.end_amdhsa_kernel
```
